```python
import torch

def _softmax(x, axis=-1):
    return torch.softmax(x, dim=axis)
def _gelu(x):
    return torch.nn.functional.gelu(x, approximate="tanh")
def _silu(x):
    return torch.nn.functional.silu(x)
def _sigmoid(x):
    return torch.sigmoid(x)
def _layernorm(x, axis=-1, eps=1e-5):
    m = x.mean(dim=axis, keepdim=True)
    v = x.var(dim=axis, keepdim=True, unbiased=False)
    return (x - m) / torch.sqrt(v + eps)
def _scatter_add(tgt, idx, src, axis=0):
    return tgt.clone().index_add_(axis, idx, src)
def _segment_sum(src, seg, n):
    out = torch.zeros((n,) + src.shape[1:], dtype=src.dtype)
    return out.index_add_(0, seg, src)
def _pad(x, pw):
    flat = tuple(v for pair in reversed(pw) for v in pair)
    return torch.nn.functional.pad(x, flat)

kernel_name = 'sequential_preLN__spectral_gfnet__glu_gated_glu__prompt'

def setup_inputs():

    _w = (lambda a: (lambda t: t.to(torch.bfloat16) if t.is_floating_point() else t)(torch.as_tensor(a)))
    def _A_setup():
        B, S, D = 1, 2048, 512
        Df = D // 2 + 1
        return {
            "x": _w((lambda *s: torch.randn(*s, dtype=torch.bfloat16) * 0.05)(B, S, D)),
            "w_r": _w((lambda *s: torch.randn(*s, dtype=torch.bfloat16) * 0.4)(S, Df) * 0.02),
            "w_i": _w((lambda *s: torch.randn(*s, dtype=torch.bfloat16) * 0.4)(S, Df) * 0.02),
        }
    _A_in = _A_setup()

    def _B_setup():
        B, S, D, F = 1, 2048, 512, 1792
        return {
            "x": _w((lambda *s: torch.randn(*s, dtype=torch.bfloat16) * 0.05)(B, S, D)),
            "w_gate": _w((lambda *s: torch.randn(*s, dtype=torch.bfloat16) * 0.05)(D, F)),
            "w_up": _w((lambda *s: torch.randn(*s, dtype=torch.bfloat16) * 0.05)(D, F)),
            "w_down": _w((lambda *s: torch.randn(*s, dtype=torch.bfloat16) * 0.05)(F, D)),
        }
    _B_in = _B_setup()

    return {
        "A_x": _A_in["x"],
        "A_w_r": _A_in["w_r"],
        "A_w_i": _A_in["w_i"],
        "B_x": _B_in["x"],
        "B_w_gate": _B_in["w_gate"],
        "B_w_up": _B_in["w_up"],
        "B_w_down": _B_in["w_down"],
    }

def reference(A_x, A_w_r, A_w_i, B_x, B_w_gate, B_w_up, B_w_down):
    def _A_ref(x, w_r, w_i):
        B, S, D = x.shape
        X = (lambda x, axes=(-2,-1): torch.fft.rfft2(x.float(), dim=axes))(x, axes=(-2, -1))
        W = w_r + 1j * w_i
        X = X * W
        y = (lambda x, s, axes=(-2,-1): torch.fft.irfft2(x, s=s, dim=axes).to(torch.bfloat16))(X, (S, D), axes=(-2, -1))
        return y

    def _B_ref(x, w_gate, w_up, w_down):
        g = torch.einsum("bsd,df->bsf", x, w_gate)
        u = torch.einsum("bsd,df->bsf", x, w_up)
        h = _sigmoid(g) * u
        return torch.einsum("bsf,fd->bsd", h, w_down)

    x = A_x
    h = x + _A_ref(_layernorm(x, axis=-1), A_w_r, A_w_i)
    h2 = h + _B_ref(_layernorm(h, axis=-1), B_w_gate, B_w_up, B_w_down)
    return h2
```

```asm
; @launch grid=(256,1,1) block=(512,1,1) lds=163840
.amdgcn_target "amdgcn-amd-amdhsa--gfx950"
.text
.globl sequential_preLN__spectral_gfnet__glu_gated_glu__prompt_kernel
.p2align 8
.type sequential_preLN__spectral_gfnet__glu_gated_glu__prompt_kernel,@function
sequential_preLN__spectral_gfnet__glu_gated_glu__prompt_kernel:
    s_cmp_ge_u32 s2, 256
    s_cbranch_scc1 L_end
    s_load_dwordx16 s[16:31], s[0:1], 0
    s_load_dwordx2 s[34:35], s[0:1], 72
    s_getpc_b64 s[4:5]
L_pc:
    s_lshr_b32 s9, s2, 3
    s_lshl_b32 s9, s9, 11
    v_lshl_add_u32 v5, v0, 2, s9
    v_min_u32 v5, L_end-L_pc, v5
    global_load_dword v255, v5, s[4:5]
    v_lshrrev_b32 v1, 6, v0
    v_and_b32 v2, 63, v0
    v_mov_b32 v3, 163808
    v_mov_b32 v4, 0
    v_readfirstlane_b32 s3, v1
    ds_write_b32 v3, v4
    ds_write_b32 v3, v4 offset:4
    ds_write_b32 v3, v4 offset:8
    ds_write_b32 v3, v4 offset:12
    ds_write_b32 v3, v4 offset:16
    ds_write_b32 v3, v4 offset:20
    ds_write_b32 v3, v4 offset:24
    ds_write_b32 v3, v4 offset:28
    s_and_b32 s8, s2, 7
    s_lshr_b32 s9, s2, 3
    s_and_b32 s36, s8, 1
    s_lshl_b32 s36, s36, 3
    s_and_b32 s10, s9, 7
    s_add_u32 s36, s36, s10
    s_lshr_b32 s37, s8, 1
    s_lshl_b32 s37, s37, 2
    s_lshr_b32 s10, s9, 3
    s_add_u32 s37, s37, s10
    s_lshr_b32 s32, s8, 1
    s_lshl_b32 s32, s32, 3
    s_and_b32 s10, s9, 7
    s_add_u32 s32, s32, s10
    s_and_b32 s33, s8, 1
    s_lshl_b32 s33, s33, 2
    s_lshr_b32 s10, s9, 3
    s_add_u32 s33, s33, s10
    s_lshl_b32 s38, s36, 4
    s_add_u32 s38, s38, s37
    s_lshl_b32 s39, s8, 5
    s_add_u32 s39, s39, s9
    s_cmp_ge_u32 s3, 4
    s_cbranch_scc1 L_helper
    v_and_b32 v3, 15, v2
    v_lshrrev_b32 v4, 4, v2
    v_cvt_f32_u32 v7, v3
    v_cvt_f32_u32 v8, v4
    v_mul_f32 v7, 0x3d000000, v7
    v_mul_f32 v8, 4.0, v8
    v_mul_f32 v16, v8, v7
    v_add_f32 v17, v16, v7
    v_add_f32 v18, v17, v7
    v_add_f32 v19, v18, v7
    v_cos_f32 v20, v16
    v_sin_f32 v24, v16
    v_cos_f32 v21, v17
    v_sin_f32 v25, v17
    v_cos_f32 v22, v18
    v_sin_f32 v26, v18
    v_cos_f32 v23, v19
    v_sin_f32 v27, v19
    v_cmp_eq_u32 s[50:51], 0, v3
    v_lshlrev_b32 v6, 31, v3
    v_lshrrev_b32 v66, 16, v6
    v_or_b32 v6, v6, v66
    v_mov_b32 v66, 0xbf803f80
    v_cvt_pk_bf16_f32 v28, v20, v21
    v_cvt_pk_bf16_f32 v32, -v24, -v25
    v_cndmask_b32 v32, v32, v66, s[50:51]
    v_xor_b32 v30, v6, v28
    v_xor_b32 v34, v6, v32
    v_cvt_pk_bf16_f32 v29, v22, v23
    v_cvt_pk_bf16_f32 v33, -v26, -v27
    v_cndmask_b32 v33, v33, v66, s[50:51]
    v_xor_b32 v31, v6, v29
    v_xor_b32 v35, v6, v33
    v_mov_b32 v66, 0xc2000000
    v_cndmask_b32 v66, 0, v66, s[50:51]
    s_lshl_b32 s8, s3, 9
    s_add_u32 s8, s8, s38
    s_lshl_b32 s9, s8, 10
    v_lshlrev_b32 v9, 4, v2
    s_lshl_b32 s10, s3, 11
    s_add_u32 s10, s10, 131072
    s_mov_b32 m0, s10
    s_waitcnt lgkmcnt(0)
    s_add_u32 s4, s16, s9
    s_addc_u32 s5, s17, 0
    s_add_u32 s6, s4, 0x40000
    s_addc_u32 s7, s5, 0
    global_load_lds_dwordx4 v9, s[4:5]
    s_add_u32 m0, s10, 1024
    s_nop 0
    global_load_lds_dwordx4 v9, s[6:7]
    s_add_u32 s48, s34, 20447232
    s_addc_u32 s49, s35, 0
    v_mov_b32 v5, 0
    global_load_dword v15, v5, s[48:49] sc1
    s_lshl_b32 s9, s39, 13
    s_lshl_b32 s11, s3, 11
    s_add_u32 s9, s9, s11
    s_add_u32 s9, s9, 24903680
    s_add_u32 s62, s34, s9
    s_addc_u32 s63, s35, 0
    s_lshl_b32 s9, s38, 13
    s_add_u32 s9, s9, s11
    s_add_u32 s9, s9, 8388608
    s_add_u32 s42, s34, s9
    s_addc_u32 s43, s35, 0
    v_mov_b32 v72, -1
    v_mov_b32 v73, -1
    v_mov_b32 v74, -1
    v_mov_b32 v75, -1
    global_store_dwordx4 v9, v[72:75], s[62:63] offset:0 sc1
    global_store_dwordx4 v9, v[72:75], s[62:63] offset:1024 sc1
    global_store_dwordx4 v9, v[72:75], s[42:43] offset:0 sc1
    global_store_dwordx4 v9, v[72:75], s[42:43] offset:1024 sc1
    s_barrier
    s_setprio 1
    v_mul_f32 v56, 0x3d800000, v16
    v_cos_f32 v52, v56
    v_sin_f32 v56, v56
    v_mul_f32 v57, 0x3d800000, v17
    v_cos_f32 v53, v57
    v_sin_f32 v57, v57
    v_mul_f32 v58, 0x3d800000, v18
    v_cos_f32 v54, v58
    v_sin_f32 v58, v58
    v_mul_f32 v59, 0x3d800000, v19
    v_cos_f32 v55, v59
    v_sin_f32 v59, v59
    v_add_f32 v16, v16, v16
    v_cos_f32 v20, v16
    v_sin_f32 v24, v16
    v_add_f32 v17, v17, v17
    v_cos_f32 v21, v17
    v_sin_f32 v25, v17
    v_add_f32 v18, v18, v18
    v_cos_f32 v22, v18
    v_sin_f32 v26, v18
    v_add_f32 v19, v19, v19
    v_cos_f32 v23, v19
    v_sin_f32 v27, v19
    v_cvt_pk_bf16_f32 v36, v20, v24
    v_cvt_pk_bf16_f32 v40, -v24, v20
    v_cvt_pk_bf16_f32 v37, v21, v25
    v_cvt_pk_bf16_f32 v41, -v25, v21
    v_cvt_pk_bf16_f32 v38, v22, v26
    v_cvt_pk_bf16_f32 v42, -v26, v22
    v_cvt_pk_bf16_f32 v39, v23, v27
    v_cvt_pk_bf16_f32 v43, -v27, v23
    v_lshlrev_b32 v6, 1, v3
    v_add_u32 v5, 1, v6
    v_cmp_gt_u32 s[52:53], 8, v3
    s_nop 1
    v_cndmask_b32 v6, v6, v5, s[52:53]
    v_cvt_f32_u32 v5, v6
    v_mul_f32 v5, 0x3d000000, v5
    v_mul_f32 v16, v8, v5
    v_add_f32 v17, v16, v5
    v_add_f32 v18, v17, v5
    v_add_f32 v19, v18, v5
    v_mov_b32 v156, 0x0c0c0100
    v_mov_b32 v6, 0x01000c0c
    v_cndmask_b32 v156, v156, v6, s[52:53]
    v_mov_b32 v157, 0x0c0c0302
    v_mov_b32 v6, 0x03020c0c
    v_cndmask_b32 v157, v157, v6, s[52:53]
    v_cos_f32 v20, v16
    v_sin_f32 v24, v16
    v_cos_f32 v21, v17
    v_sin_f32 v25, v17
    v_cos_f32 v22, v18
    v_sin_f32 v26, v18
    v_cos_f32 v23, v19
    v_sin_f32 v27, v19
    v_cvt_pk_bf16_f32 v20, v20, -v24
    v_perm_b32 v44, v20, v20, v156
    v_perm_b32 v48, v20, v20, v157
    v_cvt_pk_bf16_f32 v21, v21, -v25
    v_perm_b32 v45, v21, v21, v156
    v_perm_b32 v49, v21, v21, v157
    v_cvt_pk_bf16_f32 v22, v22, -v26
    v_perm_b32 v46, v22, v22, v156
    v_perm_b32 v50, v22, v22, v157
    v_cvt_pk_bf16_f32 v23, v23, -v27
    v_perm_b32 v47, v23, v23, v156
    v_perm_b32 v51, v23, v23, v157
    v_lshrrev_b32 v5, 1, v3
    v_lshl_add_u32 v6, v4, 9, s38
    v_mul_u32_u24 v6, v5, v6
    v_and_b32 v18, 1, v3
    v_lshl_add_u32 v6, v18, 9, v6
    v_lshl_add_u32 v5, v5, 8, v6
    v_cvt_f32_u32 v16, v6
    v_cvt_f32_u32 v17, v5
    v_mul_f32 v16, 0x3a000000, v16
    v_cos_f32 v20, v16
    v_sin_f32 v24, v16
    v_mul_f32 v17, 0x3a000000, v17
    v_cos_f32 v21, v17
    v_sin_f32 v25, v17
    v_cvt_pk_bf16_f32 v62, v20, v24
    v_cvt_pk_bf16_f32 v63, v21, v25
    v_cmp_gt_u32 s[54:55], 16, v2
    v_cmp_gt_u32 s[56:57], 32, v2
    v_lshl_add_u32 v10, v2, 3, s10
    v_lshlrev_b32 v14, 5, v3
    v_lshl_add_u32 v14, v4, 3, v14
    v_add_u32 v12, s10, v14
    s_mov_b32 s12, 0x3f803f80
    s_mul_i32 s11, s3, 2176
    s_add_u32 s11, s11, 140288
    v_lshl_add_u32 v11, v2, 5, s11
    v_mul_u32_u24 v231, 2176, v4
    v_lshl_add_u32 v231, v3, 3, v231
    s_and_b32 s9, s3, 1
    s_lshl_b32 s9, s9, 10
    s_lshr_b32 s11, s3, 1
    s_lshl_b32 s11, s11, 8
    s_add_u32 s9, s9, s11
    s_add_u32 s9, s9, 140288
    v_add_u32 v231, s9, v231
    s_lshl_b32 s11, s3, 9
    v_lshlrev_b32 v13, 12, v4
    v_lshl_add_u32 v13, v3, 4, v13
    s_lshl_b32 s9, s38, 14
    s_add_u32 s9, s9, s11
    s_add_u32 s9, s9, 0
    s_add_u32 s58, s34, s9
    s_addc_u32 s59, s35, 0
    s_waitcnt vmcnt(4)
    ds_read_b64_tr_b16 v[84:85], v10 offset:0
    ds_read_b64_tr_b16 v[86:87], v10 offset:512
    ds_read_b64_tr_b16 v[88:89], v10 offset:1024
    ds_read_b64_tr_b16 v[90:91], v10 offset:1536
    ds_read_b64 v[76:77], v12 offset:0
    ds_read_b64 v[78:79], v12 offset:512
    ds_read_b64 v[80:81], v12 offset:1024
    ds_read_b64 v[82:83], v12 offset:1536
    v_readfirstlane_b32 s40, v15
    s_nop 0
    s_add_u32 s40, s40, 1
    s_or_b32 s40, s40, 0xffff0000
    s_waitcnt lgkmcnt(6)
    v_mfma_f32_16x16x32_bf16 v[92:95], v[84:87], v[28:31], 0
    v_mfma_f32_16x16x32_bf16 v[96:99], v[84:87], v[32:35], 0
    s_waitcnt lgkmcnt(4)
    v_mfma_f32_16x16x32_bf16 v[100:103], v[88:91], v[28:31], 0
    v_mfma_f32_16x16x32_bf16 v[104:107], v[88:91], v[32:35], 0
    v_dot2_f32_bf16 v68, v84, s12, 0
    v_dot2_f32_bf16 v69, v84, v84, 0
    v_dot2_f32_bf16 v68, v85, s12, v68
    v_dot2_f32_bf16 v69, v85, v85, v69
    v_dot2_f32_bf16 v68, v86, s12, v68
    v_dot2_f32_bf16 v69, v86, v86, v69
    v_dot2_f32_bf16 v68, v87, s12, v68
    v_dot2_f32_bf16 v69, v87, v87, v69
    v_dot2_f32_bf16 v70, v88, s12, 0
    v_dot2_f32_bf16 v71, v88, v88, 0
    v_dot2_f32_bf16 v70, v89, s12, v70
    v_dot2_f32_bf16 v71, v89, v89, v71
    v_dot2_f32_bf16 v70, v90, s12, v70
    v_dot2_f32_bf16 v71, v90, v90, v71
    v_dot2_f32_bf16 v70, v91, s12, v70
    v_dot2_f32_bf16 v71, v91, v91, v71
    s_nop 1
    v_permlane32_swap_b32 v68, v70
    v_permlane32_swap_b32 v69, v71
    v_add_f32 v68, v68, v70
    v_add_f32 v69, v69, v71
    v_mov_b32 v141, s40
    s_nop 0
    v_permlane16_swap_b32 v68, v69
    v_add_f32 v68, v68, v69
    s_nop 1
    v_add_f32_dpp v68, v68, v68 quad_perm:[1,0,3,2] row_mask:0xf bank_mask:0xf
    v_mov_b32 v143, s40
    s_nop 0
    v_add_f32_dpp v68, v68, v68 quad_perm:[2,3,0,1] row_mask:0xf bank_mask:0xf
    s_nop 1
    v_add_f32_dpp v68, v68, v68 row_half_mirror row_mask:0xf bank_mask:0xf
    s_nop 1
    v_add_f32_dpp v68, v68, v68 row_mirror row_mask:0xf bank_mask:0xf
    v_mov_b32 v67, v68
    v_mov_b32 v145, s40
    s_nop 0
    v_permlane16_swap_b32 v68, v67
    v_mul_f32 v68, 0x3b000000, v68
    v_mul_f32 v67, 0x3b000000, v67
    v_mov_b32 v147, s40
    v_fma_f32 v67, -v68, v68, v67
    v_max_f32 v67, 0, v67
    v_cvt_pk_bf16_f32 v67, v67, v67
    v_mov_b32 v149, s40
    v_and_b32 v67, 0xffff0000, v67
    v_add_f32 v67, 0x3727c5ac, v67
    v_cvt_pk_bf16_f32 v67, v67, v67
    v_and_b32 v67, 0xffff0000, v67
    v_mov_b32 v151, s40
    v_sqrt_f32 v67, v67
    v_cvt_pk_bf16_f32 v68, v68, v68
    v_and_b32 v68, 0xffff0000, v68
    v_mov_b32 v153, s40
    v_cvt_pk_bf16_f32 v67, v67, v67
    v_and_b32 v67, 0xffff0000, v67
    v_rcp_f32 v67, v67
    v_mov_b32 v155, s40
    v_mul_f32 v68, v68, v67
    v_readlane_b32 s14, v67, 0
    v_readlane_b32 s15, v67, 32
    v_readlane_b32 s9, v68, 0
    v_readlane_b32 s11, v68, 32
    s_nop 0
    v_mul_f32 v60, s9, v66
    v_mul_f32 v61, s11, v66
    v_pk_fma_f32 v[92:93], v[92:93], s[14:15], v[60:61] op_sel:[0,0,0] op_sel_hi:[1,0,0]
    v_pk_mul_f32 v[96:97], v[96:97], s[14:15] op_sel:[0,0] op_sel_hi:[1,0]
    v_pk_fma_f32 v[94:95], v[94:95], s[14:15], v[60:61] op_sel:[0,0,0] op_sel_hi:[1,0,0]
    v_pk_mul_f32 v[98:99], v[98:99], s[14:15] op_sel:[0,0] op_sel_hi:[1,0]
    v_pk_mul_f32 v[20:21], v[92:93], v[52:53] op_sel:[0,0] op_sel_hi:[1,1]
    v_pk_mul_f32 v[24:25], v[96:97], v[52:53] op_sel:[0,0] op_sel_hi:[1,1]
    v_pk_fma_f32 v[20:21], v[96:97], v[56:57], v[20:21] op_sel:[0,0,0] op_sel_hi:[1,1,1]
    v_pk_fma_f32 v[24:25], v[92:93], v[56:57], v[24:25] op_sel:[0,0,0] op_sel_hi:[1,1,1] neg_lo:[1,0,0] neg_hi:[1,0,0]
    v_pk_mul_f32 v[22:23], v[94:95], v[54:55] op_sel:[0,0] op_sel_hi:[1,1]
    v_pk_mul_f32 v[26:27], v[98:99], v[54:55] op_sel:[0,0] op_sel_hi:[1,1]
    v_pk_fma_f32 v[22:23], v[98:99], v[58:59], v[22:23] op_sel:[0,0,0] op_sel_hi:[1,1,1]
    v_pk_fma_f32 v[26:27], v[94:95], v[58:59], v[26:27] op_sel:[0,0,0] op_sel_hi:[1,1,1] neg_lo:[1,0,0] neg_hi:[1,0,0]
    v_cvt_pk_bf16_f32 v84, v20, v24
    v_cvt_pk_bf16_f32 v85, v21, v25
    v_cvt_pk_bf16_f32 v86, v22, v26
    v_cvt_pk_bf16_f32 v87, v23, v27
    s_nop 1
    v_mfma_f32_16x16x32_bf16 v[108:111], v[84:87], v[36:39], 0
    v_mfma_f32_16x16x32_bf16 v[112:115], v[84:87], v[40:43], 0
    v_mfma_f32_16x16x32_bf16 v[124:127], v[84:87], v[44:47], 0
    v_mfma_f32_16x16x32_bf16 v[128:131], v[84:87], v[48:51], 0
    v_pk_fma_f32 v[100:101], v[100:101], s[14:15], v[60:61] op_sel:[0,1,1] op_sel_hi:[1,1,1]
    v_pk_mul_f32 v[104:105], v[104:105], s[14:15] op_sel:[0,1] op_sel_hi:[1,1]
    v_pk_fma_f32 v[102:103], v[102:103], s[14:15], v[60:61] op_sel:[0,1,1] op_sel_hi:[1,1,1]
    v_pk_mul_f32 v[106:107], v[106:107], s[14:15] op_sel:[0,1] op_sel_hi:[1,1]
    v_pk_mul_f32 v[20:21], v[100:101], v[52:53] op_sel:[0,0] op_sel_hi:[1,1]
    v_pk_mul_f32 v[24:25], v[104:105], v[52:53] op_sel:[0,0] op_sel_hi:[1,1]
    v_pk_fma_f32 v[20:21], v[104:105], v[56:57], v[20:21] op_sel:[0,0,0] op_sel_hi:[1,1,1]
    v_pk_fma_f32 v[24:25], v[100:101], v[56:57], v[24:25] op_sel:[0,0,0] op_sel_hi:[1,1,1] neg_lo:[1,0,0] neg_hi:[1,0,0]
    v_pk_mul_f32 v[22:23], v[102:103], v[54:55] op_sel:[0,0] op_sel_hi:[1,1]
    v_pk_mul_f32 v[26:27], v[106:107], v[54:55] op_sel:[0,0] op_sel_hi:[1,1]
    v_pk_fma_f32 v[22:23], v[106:107], v[58:59], v[22:23] op_sel:[0,0,0] op_sel_hi:[1,1,1]
    v_pk_fma_f32 v[26:27], v[102:103], v[58:59], v[26:27] op_sel:[0,0,0] op_sel_hi:[1,1,1] neg_lo:[1,0,0] neg_hi:[1,0,0]
    v_cvt_pk_bf16_f32 v88, v20, v24
    v_cvt_pk_bf16_f32 v89, v21, v25
    v_cvt_pk_bf16_f32 v90, v22, v26
    v_cvt_pk_bf16_f32 v91, v23, v27
    s_nop 1
    v_mfma_f32_16x16x32_bf16 v[116:119], v[88:91], v[36:39], 0
    v_mfma_f32_16x16x32_bf16 v[120:123], v[88:91], v[40:43], 0
    v_mfma_f32_16x16x32_bf16 v[132:135], v[88:91], v[44:47], 0
    v_mfma_f32_16x16x32_bf16 v[136:139], v[88:91], v[48:51], 0
    v_cndmask_b32 v108, v108, v124, s[54:55]
    v_cndmask_b32 v112, v112, v128, s[54:55]
    v_cvt_pk_bf16_f32 v156, v108, v112
    v_cvt_pk_bf16_f32 v158, v109, v113
    v_cvt_pk_bf16_f32 v160, v110, v114
    v_cvt_pk_bf16_f32 v162, v111, v115
    s_nop 0
    v_cndmask_b32 v116, v116, v132, s[54:55]
    v_cndmask_b32 v120, v120, v136, s[54:55]
    v_cvt_pk_bf16_f32 v157, v116, v120
    v_cvt_pk_bf16_f32 v159, v117, v121
    v_cvt_pk_bf16_f32 v161, v118, v122
    v_cvt_pk_bf16_f32 v163, v119, v123
    ds_write_b128 v11, v[156:159] offset:0
    ds_write_b128 v11, v[160:163] offset:16
    s_waitcnt vmcnt(0)
    v_mov_b32 v5, 163808
    v_mov_b32 v6, 1
    s_mov_b64 exec, 1
    ds_add_u32 v5, v6
    s_mov_b64 exec, -1
    s_mov_b32 s15, 16777216
Lms1:
    ds_read_b32 v6, v5
    s_sub_u32 s15, s15, 1
    s_cbranch_scc1 L_end
    s_waitcnt lgkmcnt(0)
    v_cmp_gt_u32 vcc, 4, v6
    s_cbranch_vccnz Lms1
    ds_read_b64 v[156:157], v231 offset:0
    ds_read_b64 v[158:159], v231 offset:512
    ds_read_b64 v[160:161], v231 offset:128
    ds_read_b64 v[162:163], v231 offset:640
    s_waitcnt lgkmcnt(3)
    v_mfma_f32_16x16x16_bf16 v[92:95], v[62:63], v[156:157], 0
    s_waitcnt lgkmcnt(2)
    v_mfma_f32_16x16x16_bf16 v[96:99], v[62:63], v[158:159], 0
    s_waitcnt lgkmcnt(1)
    v_mfma_f32_16x16x16_bf16 v[100:103], v[62:63], v[160:161], 0
    s_waitcnt lgkmcnt(0)
    v_mfma_f32_16x16x16_bf16 v[104:107], v[62:63], v[162:163], 0
    s_nop 1
    v_cvt_pk_bf16_f32 v140, v92, v93
    s_nop 0
    v_cvt_pk_bf16_f32 v142, v96, v97
    global_store_dwordx4 v13, v[140:143], s[58:59] offset:0 sc1
    v_cvt_pk_bf16_f32 v144, v94, v95
    v_cvt_pk_bf16_f32 v146, v98, v99
    global_store_dwordx4 v13, v[144:147], s[58:59] offset:2048 sc1
    v_cvt_pk_bf16_f32 v148, v100, v101
    v_cvt_pk_bf16_f32 v150, v104, v105
    global_store_dwordx4 v13, v[148:151], s[58:59] offset:256 sc1
    v_cvt_pk_bf16_f32 v152, v102, v103
    v_cvt_pk_bf16_f32 v154, v106, v107
    global_store_dwordx4 v13, v[152:155], s[58:59] offset:2304 sc1
    v_mul_f32 v16, v8, v7
    v_add_f32 v17, v16, v7
    v_add_f32 v18, v17, v7
    v_add_f32 v19, v18, v7
    v_mul_f32 v168, 0x3e000000, v16
    v_cos_f32 v164, v168
    v_sin_f32 v168, v168
    v_mul_f32 v169, 0x3e000000, v17
    v_cos_f32 v165, v169
    v_sin_f32 v169, v169
    v_mul_f32 v170, 0x3e000000, v18
    v_cos_f32 v166, v170
    v_sin_f32 v170, v170
    v_mul_f32 v171, 0x3e000000, v19
    v_cos_f32 v167, v171
    v_sin_f32 v171, v171
    v_lshrrev_b32 v5, 2, v2
    v_and_b32 v6, 3, v2
    v_lshlrev_b32 v228, 14, v5
    v_lshl_add_u32 v228, v6, 4, v228
    v_add_u32 v229, 0x40000, v228
    v_mul_u32_u24 v230, 2080, v6
    v_lshl_add_u32 v230, v5, 4, v230
    s_lshl_b32 s11, s3, 8
    s_add_u32 s9, s11, 131072
    v_add_u32 v230, s9, v230
    s_mul_i32 s9, s3, 2080
    s_add_u32 s9, s9, 131072
    v_add_u32 v231, s9, v9
    v_and_b32 v6, 1, v2
    v_mul_u32_u24 v232, 4160, v6
    v_bfe_u32 v5, v2, 1, 4
    v_lshl_add_u32 v232, v5, 4, v232
    v_lshrrev_b32 v5, 5, v2
    v_lshl_add_u32 v232, v5, 2, v232
    s_add_u32 s9, s11, 140288
    v_add_u32 v232, s9, v232
    s_lshl_b32 s9, s3, 20
    s_lshl_b32 s11, s39, 6
    s_add_u32 s9, s9, s11
    s_add_u32 s9, s9, 0
    s_add_u32 s4, s34, s9
    s_addc_u32 s5, s35, 0
    s_add_u32 s6, s4, 0x80000
    s_addc_u32 s7, s5, 0
    s_bitcmp1_b32 s39, 4
    s_cselect_b32 s9, 7, 0
    s_cselect_b32 s13, 0x80000000, 0
    s_xor_b32 s9, s9, s3
    s_lshl_b32 s9, s9, 1
    s_add_u32 s9, s9, 149504
    v_lshlrev_b32 v10, 10, v4
    v_lshl_add_u32 v10, v3, 4, v10
    v_add_u32 v10, s9, v10
    v_xor_b32 v11, 8, v10
    v_mov_b32 v5, 163808
    s_sleep 24
    s_waitcnt vmcnt(0)
    v_mov_b32 v5, 163808
    v_mov_b32 v6, 1
    s_mov_b64 exec, 1
    ds_add_u32 v5, v6 offset:12
    s_mov_b64 exec, -1
    global_load_dwordx4 v[140:143], v228, s[4:5] sc1
    global_load_dwordx4 v[144:147], v229, s[4:5] sc1
    global_load_dwordx4 v[148:151], v228, s[6:7] sc1
    global_load_dwordx4 v[152:155], v229, s[6:7] sc1
    v_mov_b32 v5, 163808
    s_mov_b32 s15, 16777216
Lww2:
    ds_read_b32 v6, v5 offset:8
    s_sub_u32 s15, s15, 1
    s_cbranch_scc1 L_end
    s_waitcnt lgkmcnt(0)
    v_cmp_gt_u32 vcc, 4, v6
    s_cbranch_vccnz Lww2
    ds_read_u16 v172, v10 offset:0
    ds_read_u16 v173, v10 offset:256
    ds_read_u16 v174, v10 offset:512
    ds_read_u16 v175, v10 offset:768
    ds_read_u16 v176, v11 offset:0
    ds_read_u16 v177, v11 offset:256
    ds_read_u16 v178, v11 offset:512
    ds_read_u16 v179, v11 offset:768
    s_waitcnt lgkmcnt(0)
    v_lshlrev_b32 v172, 16, v172
    v_lshlrev_b32 v173, 16, v173
    v_lshlrev_b32 v174, 16, v174
    v_lshlrev_b32 v175, 16, v175
    v_lshlrev_b32 v176, 16, v176
    v_lshlrev_b32 v177, 16, v177
    v_lshlrev_b32 v178, 16, v178
    v_lshlrev_b32 v179, 16, v179
    ds_read_u16 v180, v10 offset:4096
    ds_read_u16 v181, v10 offset:4352
    ds_read_u16 v182, v10 offset:4608
    ds_read_u16 v183, v10 offset:4864
    ds_read_u16 v184, v11 offset:4096
    ds_read_u16 v185, v11 offset:4352
    ds_read_u16 v186, v11 offset:4608
    ds_read_u16 v187, v11 offset:4864
    s_waitcnt lgkmcnt(0)
    v_lshlrev_b32 v180, 16, v180
    v_xor_b32 v180, s13, v180
    v_lshlrev_b32 v181, 16, v181
    v_xor_b32 v181, s13, v181
    v_lshlrev_b32 v182, 16, v182
    v_xor_b32 v182, s13, v182
    v_lshlrev_b32 v183, 16, v183
    v_xor_b32 v183, s13, v183
    v_lshlrev_b32 v184, 16, v184
    v_xor_b32 v184, s13, v184
    v_lshlrev_b32 v185, 16, v185
    v_xor_b32 v185, s13, v185
    v_lshlrev_b32 v186, 16, v186
    v_xor_b32 v186, s13, v186
    v_lshlrev_b32 v187, 16, v187
    v_xor_b32 v187, s13, v187
    s_waitcnt vmcnt(0)
    v_and_b32 v5, v141, v143
    v_or_b32 v6, v141, v143
    v_bitop3_b32 v5, v5, v145, v147 bitop3:0x80
    v_or3_b32 v6, v6, v145, v147
    v_bitop3_b32 v5, v5, v149, v151 bitop3:0x80
    v_or3_b32 v6, v6, v149, v151
    v_bitop3_b32 v5, v5, v153, v155 bitop3:0x80
    v_or3_b32 v6, v6, v153, v155
    v_xor_b32 v5, s40, v5
    v_xor_b32 v6, s40, v6
    v_or_b32 v5, v5, v6
    v_cmp_ne_u32 vcc, 0, v5
    s_cbranch_vccnz Lpoll3
Lok4:
    v_mov_b32 v156, v140
    v_mov_b32 v157, v144
    v_mov_b32 v158, v148
    v_mov_b32 v159, v152
    ds_write_b128 v230, v[156:159] offset:0
    v_mov_b32 v160, v142
    v_mov_b32 v161, v146
    v_mov_b32 v162, v150
    v_mov_b32 v163, v154
    ds_write_b128 v230, v[160:163] offset:1024
    v_mov_b32 v5, 163808
    v_mov_b32 v6, 1
    s_mov_b64 exec, 1
    ds_add_u32 v5, v6
    s_mov_b64 exec, -1
    s_mov_b32 s15, 16777216
Lms5:
    ds_read_b32 v6, v5
    s_sub_u32 s15, s15, 1
    s_cbranch_scc1 L_end
    s_waitcnt lgkmcnt(0)
    v_cmp_gt_u32 vcc, 8, v6
    s_cbranch_vccnz Lms5
    ds_read_b128 v[84:87], v231 offset:0
    ds_read_b128 v[88:91], v231 offset:1024
    s_waitcnt lgkmcnt(1)
    v_mfma_f32_16x16x32_bf16 v[92:95], v[84:87], v[36:39], 0
    v_mfma_f32_16x16x32_bf16 v[96:99], v[84:87], v[40:43], 0
    s_waitcnt lgkmcnt(0)
    v_mfma_f32_16x16x32_bf16 v[100:103], v[88:91], v[36:39], 0
    v_mfma_f32_16x16x32_bf16 v[104:107], v[88:91], v[40:43], 0
    s_nop 3
    v_pk_mul_f32 v[20:21], v[92:93], v[164:165] op_sel:[0,0] op_sel_hi:[1,1]
    v_pk_mul_f32 v[24:25], v[96:97], v[164:165] op_sel:[0,0] op_sel_hi:[1,1]
    v_pk_fma_f32 v[20:21], v[96:97], v[168:169], v[20:21] op_sel:[0,0,0] op_sel_hi:[1,1,1]
    v_pk_fma_f32 v[24:25], v[92:93], v[168:169], v[24:25] op_sel:[0,0,0] op_sel_hi:[1,1,1] neg_lo:[1,0,0] neg_hi:[1,0,0]
    v_pk_mul_f32 v[22:23], v[94:95], v[166:167] op_sel:[0,0] op_sel_hi:[1,1]
    v_pk_mul_f32 v[26:27], v[98:99], v[166:167] op_sel:[0,0] op_sel_hi:[1,1]
    v_pk_fma_f32 v[22:23], v[98:99], v[170:171], v[22:23] op_sel:[0,0,0] op_sel_hi:[1,1,1]
    v_pk_fma_f32 v[26:27], v[94:95], v[170:171], v[26:27] op_sel:[0,0,0] op_sel_hi:[1,1,1] neg_lo:[1,0,0] neg_hi:[1,0,0]
    v_cvt_pk_bf16_f32 v84, v20, v24
    v_cvt_pk_bf16_f32 v85, v21, v25
    v_cvt_pk_bf16_f32 v86, v22, v26
    v_cvt_pk_bf16_f32 v87, v23, v27
    s_nop 1
    v_mfma_f32_16x16x32_bf16 v[108:111], v[36:39], v[84:87], 0
    v_mfma_f32_16x16x32_bf16 v[112:115], v[40:43], v[84:87], 0
    v_pk_mul_f32 v[124:125], v[100:101], v[164:165] op_sel:[0,0] op_sel_hi:[1,1]
    v_pk_mul_f32 v[128:129], v[104:105], v[164:165] op_sel:[0,0] op_sel_hi:[1,1]
    v_pk_fma_f32 v[124:125], v[104:105], v[168:169], v[124:125] op_sel:[0,0,0] op_sel_hi:[1,1,1]
    v_pk_fma_f32 v[128:129], v[100:101], v[168:169], v[128:129] op_sel:[0,0,0] op_sel_hi:[1,1,1] neg_lo:[1,0,0] neg_hi:[1,0,0]
    v_pk_mul_f32 v[126:127], v[102:103], v[166:167] op_sel:[0,0] op_sel_hi:[1,1]
    v_pk_mul_f32 v[130:131], v[106:107], v[166:167] op_sel:[0,0] op_sel_hi:[1,1]
    v_pk_fma_f32 v[126:127], v[106:107], v[170:171], v[126:127] op_sel:[0,0,0] op_sel_hi:[1,1,1]
    v_pk_fma_f32 v[130:131], v[102:103], v[170:171], v[130:131] op_sel:[0,0,0] op_sel_hi:[1,1,1] neg_lo:[1,0,0] neg_hi:[1,0,0]
    v_cvt_pk_bf16_f32 v88, v124, v128
    v_cvt_pk_bf16_f32 v89, v125, v129
    v_cvt_pk_bf16_f32 v90, v126, v130
    v_cvt_pk_bf16_f32 v91, v127, v131
    s_nop 1
    v_mfma_f32_16x16x32_bf16 v[116:119], v[36:39], v[88:91], 0
    v_mfma_f32_16x16x32_bf16 v[120:123], v[40:43], v[88:91], 0
    v_pk_mul_f32 v[20:21], v[108:109], v[172:173] op_sel:[0,0] op_sel_hi:[1,1]
    v_pk_mul_f32 v[24:25], v[112:113], v[172:173] op_sel:[0,0] op_sel_hi:[1,1]
    v_pk_fma_f32 v[20:21], v[112:113], v[180:181], v[20:21] op_sel:[0,0,0] op_sel_hi:[1,1,1] neg_lo:[1,0,0] neg_hi:[1,0,0]
    v_pk_fma_f32 v[24:25], v[108:109], v[180:181], v[24:25] op_sel:[0,0,0] op_sel_hi:[1,1,1]
    v_pk_mul_f32 v[22:23], v[110:111], v[174:175] op_sel:[0,0] op_sel_hi:[1,1]
    v_pk_mul_f32 v[26:27], v[114:115], v[174:175] op_sel:[0,0] op_sel_hi:[1,1]
    v_pk_fma_f32 v[22:23], v[114:115], v[182:183], v[22:23] op_sel:[0,0,0] op_sel_hi:[1,1,1] neg_lo:[1,0,0] neg_hi:[1,0,0]
    v_pk_fma_f32 v[26:27], v[110:111], v[182:183], v[26:27] op_sel:[0,0,0] op_sel_hi:[1,1,1]
    v_cvt_pk_bf16_f32 v84, v24, v20
    v_cvt_pk_bf16_f32 v85, v25, v21
    v_cvt_pk_bf16_f32 v86, v26, v22
    v_cvt_pk_bf16_f32 v87, v27, v23
    v_pk_mul_f32 v[124:125], v[116:117], v[176:177] op_sel:[0,0] op_sel_hi:[1,1]
    v_pk_mul_f32 v[128:129], v[120:121], v[176:177] op_sel:[0,0] op_sel_hi:[1,1]
    v_pk_fma_f32 v[124:125], v[120:121], v[184:185], v[124:125] op_sel:[0,0,0] op_sel_hi:[1,1,1] neg_lo:[1,0,0] neg_hi:[1,0,0]
    v_pk_fma_f32 v[128:129], v[116:117], v[184:185], v[128:129] op_sel:[0,0,0] op_sel_hi:[1,1,1]
    v_pk_mul_f32 v[126:127], v[118:119], v[178:179] op_sel:[0,0] op_sel_hi:[1,1]
    v_pk_mul_f32 v[130:131], v[122:123], v[178:179] op_sel:[0,0] op_sel_hi:[1,1]
    v_pk_fma_f32 v[126:127], v[122:123], v[186:187], v[126:127] op_sel:[0,0,0] op_sel_hi:[1,1,1] neg_lo:[1,0,0] neg_hi:[1,0,0]
    v_pk_fma_f32 v[130:131], v[118:119], v[186:187], v[130:131] op_sel:[0,0,0] op_sel_hi:[1,1,1]
    v_cvt_pk_bf16_f32 v88, v128, v124
    v_cvt_pk_bf16_f32 v89, v129, v125
    v_cvt_pk_bf16_f32 v90, v130, v126
    v_cvt_pk_bf16_f32 v91, v131, v127
    v_mfma_f32_16x16x32_bf16 v[92:95], v[84:87], v[36:39], 0
    v_mfma_f32_16x16x32_bf16 v[96:99], v[84:87], v[40:43], 0
    v_mfma_f32_16x16x32_bf16 v[100:103], v[88:91], v[36:39], 0
    v_mfma_f32_16x16x32_bf16 v[104:107], v[88:91], v[40:43], 0
    s_nop 4
    v_pk_mul_f32 v[20:21], v[92:93], v[164:165] op_sel:[0,0] op_sel_hi:[1,1]
    v_pk_mul_f32 v[24:25], v[96:97], v[164:165] op_sel:[0,0] op_sel_hi:[1,1]
    v_pk_fma_f32 v[20:21], v[96:97], v[168:169], v[20:21] op_sel:[0,0,0] op_sel_hi:[1,1,1]
    v_pk_fma_f32 v[24:25], v[92:93], v[168:169], v[24:25] op_sel:[0,0,0] op_sel_hi:[1,1,1] neg_lo:[1,0,0] neg_hi:[1,0,0]
    v_pk_mul_f32 v[22:23], v[94:95], v[166:167] op_sel:[0,0] op_sel_hi:[1,1]
    v_pk_mul_f32 v[26:27], v[98:99], v[166:167] op_sel:[0,0] op_sel_hi:[1,1]
    v_pk_fma_f32 v[22:23], v[98:99], v[170:171], v[22:23] op_sel:[0,0,0] op_sel_hi:[1,1,1]
    v_pk_fma_f32 v[26:27], v[94:95], v[170:171], v[26:27] op_sel:[0,0,0] op_sel_hi:[1,1,1] neg_lo:[1,0,0] neg_hi:[1,0,0]
    v_cvt_pk_bf16_f32 v84, v20, v24
    v_cvt_pk_bf16_f32 v85, v21, v25
    v_cvt_pk_bf16_f32 v86, v22, v26
    v_cvt_pk_bf16_f32 v87, v23, v27
    s_nop 1
    v_mfma_f32_16x16x32_bf16 v[108:111], v[36:39], v[84:87], 0
    v_mfma_f32_16x16x32_bf16 v[112:115], v[40:43], v[84:87], 0
    v_pk_mul_f32 v[124:125], v[100:101], v[164:165] op_sel:[0,0] op_sel_hi:[1,1]
    v_pk_mul_f32 v[128:129], v[104:105], v[164:165] op_sel:[0,0] op_sel_hi:[1,1]
    v_pk_fma_f32 v[124:125], v[104:105], v[168:169], v[124:125] op_sel:[0,0,0] op_sel_hi:[1,1,1]
    v_pk_fma_f32 v[128:129], v[100:101], v[168:169], v[128:129] op_sel:[0,0,0] op_sel_hi:[1,1,1] neg_lo:[1,0,0] neg_hi:[1,0,0]
    v_pk_mul_f32 v[126:127], v[102:103], v[166:167] op_sel:[0,0] op_sel_hi:[1,1]
    v_pk_mul_f32 v[130:131], v[106:107], v[166:167] op_sel:[0,0] op_sel_hi:[1,1]
    v_pk_fma_f32 v[126:127], v[106:107], v[170:171], v[126:127] op_sel:[0,0,0] op_sel_hi:[1,1,1]
    v_pk_fma_f32 v[130:131], v[102:103], v[170:171], v[130:131] op_sel:[0,0,0] op_sel_hi:[1,1,1] neg_lo:[1,0,0] neg_hi:[1,0,0]
    v_cvt_pk_bf16_f32 v88, v124, v128
    v_cvt_pk_bf16_f32 v89, v125, v129
    v_cvt_pk_bf16_f32 v90, v126, v130
    v_cvt_pk_bf16_f32 v91, v127, v131
    s_nop 1
    v_mfma_f32_16x16x32_bf16 v[116:119], v[36:39], v[88:91], 0
    v_mfma_f32_16x16x32_bf16 v[120:123], v[40:43], v[88:91], 0
    v_cvt_pk_bf16_f32 v156, v112, v108
    v_cvt_pk_bf16_f32 v157, v113, v109
    v_cvt_pk_bf16_f32 v158, v114, v110
    v_cvt_pk_bf16_f32 v159, v115, v111
    ds_write_b128 v231, v[156:159] offset:9216
    s_nop 2
    v_cvt_pk_bf16_f32 v160, v120, v116
    v_cvt_pk_bf16_f32 v161, v121, v117
    v_cvt_pk_bf16_f32 v162, v122, v118
    v_cvt_pk_bf16_f32 v163, v123, v119
    ds_write_b128 v231, v[160:163] offset:10240
    v_add_u32 v233, 2080, v232
    v_add_u32 v230, 8, v232
    v_add_u32 v10, 8, v233
    s_waitcnt vmcnt(0)
    v_mov_b32 v5, 163808
    v_mov_b32 v6, 1
    s_mov_b64 exec, 1
    ds_add_u32 v5, v6
    s_mov_b64 exec, -1
    s_mov_b32 s15, 16777216
Lms6:
    ds_read_b32 v6, v5
    s_sub_u32 s15, s15, 1
    s_cbranch_scc1 L_end
    s_waitcnt lgkmcnt(0)
    v_cmp_gt_u32 vcc, 12, v6
    s_cbranch_vccnz Lms6
    ds_read2st64_b32 v[140:141], v232 offset0:0 offset1:4
    ds_read2st64_b32 v[142:143], v233 offset0:0 offset1:4
    ds_read2st64_b32 v[144:145], v230 offset0:0 offset1:4
    ds_read2st64_b32 v[146:147], v10 offset0:0 offset1:4
    s_waitcnt lgkmcnt(2)
    global_store_dwordx4 v9, v[140:143], s[62:63] offset:0 sc1
    s_waitcnt lgkmcnt(0)
    global_store_dwordx4 v9, v[144:147], s[62:63] offset:1024 sc1
    s_lshl_b32 s9, s8, 10
    s_add_u32 s9, s9, 6291456
    s_add_u32 s58, s34, s9
    s_addc_u32 s59, s35, 0
    s_add_u32 s60, s58, 0x40000
    s_addc_u32 s61, s59, 0
    v_lshlrev_b32 v240, 19, v4
    v_lshrrev_b32 v5, 1, v3
    v_lshl_add_u32 v240, v5, 13, v240
    v_and_b32 v6, 1, v2
    v_lshl_add_u32 v240, v6, 4, v240
    s_lshl_b32 s9, s3, 16
    s_lshl_b32 s11, s38, 5
    s_add_u32 s9, s9, s11
    s_add_u32 s9, s9, 24903680
    v_mul_u32_u24 v234, 2064, v4
    v_lshl_add_u32 v234, v6, 5, v234
    v_and_b32 v5, 3, v5
    v_lshl_add_u32 v234, v5, 2, v234
    v_bfe_u32 v5, v2, 3, 1
    v_lshl_add_u32 v234, v5, 8, v234
    s_and_b32 s11, s3, 1
    s_lshl_b32 s11, s11, 7
    s_lshr_b32 s13, s3, 1
    s_lshl_b32 s13, s13, 9
    s_add_u32 s11, s11, s13
    s_add_u32 s11, s11, 131072
    v_add_u32 v234, s11, v234
    v_add_u32 v235, 16, v234
    v_add_u32 v236, 64, v234
    v_add_u32 v237, 80, v234
    s_mul_i32 s11, s3, 2064
    s_add_u32 s11, s11, 131072
    v_add_u32 v238, s11, v9
    s_add_u32 s4, s34, s9
    s_addc_u32 s5, s35, 0
    s_add_u32 s6, s4, 0x40000
    s_addc_u32 s7, s5, 0
    v_bfe_u32 v239, v2, 1, 4
    v_lshlrev_b32 v239, 7, v239
    v_lshrrev_b32 v5, 5, v2
    v_lshl_add_u32 v239, v5, 5, v239
    v_lshl_add_u32 v239, v6, 4, v239
    s_lshl_b32 s9, s38, 13
    s_lshr_b32 s11, s3, 1
    s_lshl_b32 s11, s11, 12
    s_add_u32 s9, s9, s11
    s_and_b32 s11, s3, 1
    s_lshl_b32 s11, s11, 6
    s_add_u32 s9, s9, s11
    s_add_u32 s9, s9, 8388608
    s_add_u32 s62, s34, s9
    s_addc_u32 s63, s35, 0
    v_mul_f32 v16, v8, v7
    v_add_f32 v17, v16, v7
    v_add_f32 v18, v17, v7
    v_add_f32 v19, v18, v7
    v_cos_f32 v20, v16
    v_sin_f32 v24, v16
    v_cos_f32 v21, v17
    v_sin_f32 v25, v17
    v_cos_f32 v22, v18
    v_sin_f32 v26, v18
    v_cos_f32 v23, v19
    v_sin_f32 v27, v19
    v_lshlrev_b32 v5, 31, v3
    v_xor_b32 v5, 0x3f803f80, v5
    v_cvt_pk_bf16_f32 v204, v20, -v24
    v_cvt_pk_bf16_f32 v205, v21, -v25
    v_cvt_pk_bf16_f32 v206, v22, -v26
    v_cvt_pk_bf16_f32 v207, v23, -v27
    v_cndmask_b32 v204, v204, v5, s[54:55]
    v_mov_b32 v208, v204
    v_xor_b32 v209, 0x80008000, v205
    v_mov_b32 v210, v206
    v_xor_b32 v211, 0x80008000, v207
    v_mul_f32 v52, 0x36000000, v52
    v_mul_f32 v56, 0x36000000, v56
    v_mul_f32 v53, 0x36000000, v53
    v_mul_f32 v57, 0x36000000, v57
    v_mul_f32 v54, 0x36000000, v54
    v_mul_f32 v58, 0x36000000, v58
    v_mul_f32 v55, 0x36000000, v55
    v_mul_f32 v59, 0x36000000, v59
    v_xor_b32 v188, 0x80000000, v36
    v_xor_b32 v192, 0x8000, v40
    v_xor_b32 v189, 0x80000000, v37
    v_xor_b32 v193, 0x8000, v41
    v_xor_b32 v190, 0x80000000, v38
    v_xor_b32 v194, 0x8000, v42
    v_xor_b32 v191, 0x80000000, v39
    v_xor_b32 v195, 0x8000, v43
    v_fma_f32 v16, v16, 2.0, v7
    v_cos_f32 v20, v16
    v_sin_f32 v24, v16
    v_fma_f32 v17, v17, 2.0, v7
    v_cos_f32 v21, v17
    v_sin_f32 v25, v17
    v_fma_f32 v18, v18, 2.0, v7
    v_cos_f32 v22, v18
    v_sin_f32 v26, v18
    v_fma_f32 v19, v19, 2.0, v7
    v_cos_f32 v23, v19
    v_sin_f32 v27, v19
    v_lshlrev_b32 v5, 15, v3
    v_and_b32 v5, 0x8000, v5
    v_or_b32 v5, 0x3f00, v5
    v_cvt_pk_bf16_f32 v200, v20, -v24
    v_cndmask_b32 v200, 0, v200, s[56:57]
    v_cndmask_b32 v196, v188, 0, s[56:57]
    v_cvt_pk_bf16_f32 v201, v21, -v25
    v_cndmask_b32 v201, 0, v201, s[56:57]
    v_cndmask_b32 v197, v189, 0, s[56:57]
    v_cvt_pk_bf16_f32 v202, v22, -v26
    v_cndmask_b32 v202, 0, v202, s[56:57]
    v_cndmask_b32 v198, v190, 0, s[56:57]
    v_cvt_pk_bf16_f32 v203, v23, -v27
    v_cndmask_b32 v203, 0, v203, s[56:57]
    v_cndmask_b32 v199, v191, 0, s[56:57]
    v_cmp_eq_u32 vcc, 2, v4
    s_nop 1
    v_cndmask_b32 v196, v196, v5, vcc
    v_lshrrev_b32 v5, 1, v3
    v_lshl_add_u32 v5, v5, 8, s38
    v_lshlrev_b32 v6, 1, v4
    v_mul_u32_u24 v6, v5, v6
    v_and_b32 v18, 1, v3
    v_mul_u32_u24 v18, 1536, v18
    v_add_u32 v6, v6, v18
    v_add_u32 v5, v5, v6
    v_cvt_f32_u32 v16, v6
    v_cvt_f32_u32 v17, v5
    v_mul_f32 v16, 0x3a000000, v16
    v_cos_f32 v20, v16
    v_sin_f32 v24, v16
    v_mul_f32 v17, 0x3a000000, v17
    v_cos_f32 v21, v17
    v_sin_f32 v25, v17
    v_cvt_pk_bf16_f32 v64, v20, -v24
    v_cvt_pk_bf16_f32 v65, v21, -v25
    v_lshlrev_b32 v212, 16, v76
    v_and_b32 v213, 0xffff0000, v76
    v_lshlrev_b32 v214, 16, v77
    v_and_b32 v215, 0xffff0000, v77
    v_lshlrev_b32 v216, 16, v78
    v_and_b32 v217, 0xffff0000, v78
    v_lshlrev_b32 v218, 16, v79
    v_and_b32 v219, 0xffff0000, v79
    v_lshlrev_b32 v220, 16, v80
    v_and_b32 v221, 0xffff0000, v80
    v_lshlrev_b32 v222, 16, v81
    v_and_b32 v223, 0xffff0000, v81
    v_lshlrev_b32 v224, 16, v82
    v_and_b32 v225, 0xffff0000, v82
    v_lshlrev_b32 v226, 16, v83
    v_and_b32 v227, 0xffff0000, v83
    s_sleep 20
    s_waitcnt vmcnt(0)
    v_mov_b32 v5, 163808
    v_mov_b32 v6, 1
    s_mov_b64 exec, 1
    ds_add_u32 v5, v6 offset:12
    s_mov_b64 exec, -1
    global_load_dwordx4 v[148:151], v240, s[4:5] sc1
    global_load_dwordx4 v[152:155], v240, s[6:7] sc1
    s_waitcnt vmcnt(0)
    v_max3_u32 v5, v149, v151, v153
    v_max_u32 v5, v5, v155
    v_cmp_le_u32 vcc, 0xffff0000, v5
    s_cbranch_vccnz Lpoll7
Lok8:
    v_swap_b32 v149, v152
    v_swap_b32 v151, v154
    s_nop 0
    v_mfma_f32_16x16x16_bf16 v[92:95], v[64:65], v[148:149], 0
    v_mfma_f32_16x16x16_bf16 v[96:99], v[64:65], v[150:151], 0
    v_mfma_f32_16x16x16_bf16 v[100:103], v[64:65], v[152:153], 0
    v_mfma_f32_16x16x16_bf16 v[104:107], v[64:65], v[154:155], 0
    s_nop 4
    v_cvt_pk_bf16_f32 v156, v92, v93
    v_cvt_pk_bf16_f32 v157, v94, v95
    ds_write2st64_b32 v234, v156, v157 offset0:0 offset1:4
    v_cvt_pk_bf16_f32 v158, v96, v97
    v_cvt_pk_bf16_f32 v159, v98, v99
    ds_write2st64_b32 v235, v158, v159 offset0:0 offset1:4
    v_cvt_pk_bf16_f32 v160, v100, v101
    v_cvt_pk_bf16_f32 v161, v102, v103
    ds_write2st64_b32 v236, v160, v161 offset0:0 offset1:4
    v_cvt_pk_bf16_f32 v162, v104, v105
    v_cvt_pk_bf16_f32 v163, v106, v107
    ds_write2st64_b32 v237, v162, v163 offset0:0 offset1:4
    v_mov_b32 v5, 163808
    v_mov_b32 v6, 1
    s_mov_b64 exec, 1
    ds_add_u32 v5, v6
    s_mov_b64 exec, -1
    s_mov_b32 s15, 16777216
Lms9:
    ds_read_b32 v6, v5
    s_sub_u32 s15, s15, 1
    s_cbranch_scc1 L_end
    s_waitcnt lgkmcnt(0)
    v_cmp_gt_u32 vcc, 16, v6
    s_cbranch_vccnz Lms9
    ds_read_b128 v[84:87], v238 offset:0
    ds_read_b128 v[88:91], v238 offset:1024
    s_waitcnt lgkmcnt(1)
    v_mfma_f32_16x16x32_bf16 v[92:95], v[84:87], v[188:191], 0
    v_mfma_f32_16x16x32_bf16 v[96:99], v[84:87], v[192:195], 0
    v_mfma_f32_16x16x32_bf16 v[124:127], v[84:87], v[196:199], 0
    v_mfma_f32_16x16x32_bf16 v[128:131], v[84:87], v[200:203], 0
    s_waitcnt lgkmcnt(0)
    v_mfma_f32_16x16x32_bf16 v[100:103], v[88:91], v[188:191], 0
    v_mfma_f32_16x16x32_bf16 v[104:107], v[88:91], v[192:195], 0
    v_mfma_f32_16x16x32_bf16 v[132:135], v[88:91], v[196:199], 0
    v_mfma_f32_16x16x32_bf16 v[136:139], v[88:91], v[200:203], 0
    s_nop 1
    v_cndmask_b32 v92, v92, v124, s[54:55]
    v_cndmask_b32 v96, v96, v128, s[54:55]
    v_pk_mul_f32 v[20:21], v[92:93], v[52:53] op_sel:[0,0] op_sel_hi:[1,1]
    v_pk_mul_f32 v[24:25], v[96:97], v[52:53] op_sel:[0,0] op_sel_hi:[1,1]
    v_pk_fma_f32 v[20:21], v[96:97], v[56:57], v[20:21] op_sel:[0,0,0] op_sel_hi:[1,1,1] neg_lo:[1,0,0] neg_hi:[1,0,0]
    v_pk_fma_f32 v[24:25], v[92:93], v[56:57], v[24:25] op_sel:[0,0,0] op_sel_hi:[1,1,1]
    v_pk_mul_f32 v[22:23], v[94:95], v[54:55] op_sel:[0,0] op_sel_hi:[1,1]
    v_pk_mul_f32 v[26:27], v[98:99], v[54:55] op_sel:[0,0] op_sel_hi:[1,1]
    v_pk_fma_f32 v[22:23], v[98:99], v[58:59], v[22:23] op_sel:[0,0,0] op_sel_hi:[1,1,1] neg_lo:[1,0,0] neg_hi:[1,0,0]
    v_pk_fma_f32 v[26:27], v[94:95], v[58:59], v[26:27] op_sel:[0,0,0] op_sel_hi:[1,1,1]
    v_cvt_pk_bf16_f32 v84, v20, v24
    v_cvt_pk_bf16_f32 v85, v21, v25
    v_cvt_pk_bf16_f32 v86, v22, v26
    v_cvt_pk_bf16_f32 v87, v23, v27
    s_nop 1
    v_mfma_f32_16x16x32_bf16 v[108:111], v[84:87], v[204:207], 0
    v_mfma_f32_16x16x32_bf16 v[112:115], v[84:87], v[208:211], 0
    v_cndmask_b32 v100, v100, v132, s[54:55]
    v_cndmask_b32 v104, v104, v136, s[54:55]
    v_pk_mul_f32 v[20:21], v[100:101], v[52:53] op_sel:[0,0] op_sel_hi:[1,1]
    v_pk_mul_f32 v[24:25], v[104:105], v[52:53] op_sel:[0,0] op_sel_hi:[1,1]
    v_pk_fma_f32 v[20:21], v[104:105], v[56:57], v[20:21] op_sel:[0,0,0] op_sel_hi:[1,1,1] neg_lo:[1,0,0] neg_hi:[1,0,0]
    v_pk_fma_f32 v[24:25], v[100:101], v[56:57], v[24:25] op_sel:[0,0,0] op_sel_hi:[1,1,1]
    v_pk_mul_f32 v[22:23], v[102:103], v[54:55] op_sel:[0,0] op_sel_hi:[1,1]
    v_pk_mul_f32 v[26:27], v[106:107], v[54:55] op_sel:[0,0] op_sel_hi:[1,1]
    v_pk_fma_f32 v[22:23], v[106:107], v[58:59], v[22:23] op_sel:[0,0,0] op_sel_hi:[1,1,1] neg_lo:[1,0,0] neg_hi:[1,0,0]
    v_pk_fma_f32 v[26:27], v[102:103], v[58:59], v[26:27] op_sel:[0,0,0] op_sel_hi:[1,1,1]
    v_cvt_pk_bf16_f32 v88, v20, v24
    v_cvt_pk_bf16_f32 v89, v21, v25
    v_cvt_pk_bf16_f32 v90, v22, v26
    v_cvt_pk_bf16_f32 v91, v23, v27
    s_nop 1
    v_mfma_f32_16x16x32_bf16 v[116:119], v[88:91], v[204:207], 0
    v_mfma_f32_16x16x32_bf16 v[120:123], v[88:91], v[208:211], 0
    v_cvt_pk_bf16_f32 v109, v108, v109
    v_cvt_pk_bf16_f32 v111, v110, v111
    v_cvt_pk_bf16_f32 v113, v112, v113
    v_cvt_pk_bf16_f32 v115, v114, v115
    v_lshlrev_b32 v108, 16, v109
    v_and_b32 v109, 0xffff0000, v109
    v_lshlrev_b32 v110, 16, v111
    v_and_b32 v111, 0xffff0000, v111
    v_lshlrev_b32 v112, 16, v113
    v_and_b32 v113, 0xffff0000, v113
    v_lshlrev_b32 v114, 16, v115
    v_and_b32 v115, 0xffff0000, v115
    v_pk_add_f32 v[108:109], v[108:109], v[212:213]
    v_pk_add_f32 v[110:111], v[110:111], v[214:215]
    v_pk_add_f32 v[112:113], v[112:113], v[216:217]
    v_pk_add_f32 v[114:115], v[114:115], v[218:219]
    v_cvt_pk_bf16_f32 v76, v108, v109
    v_cvt_pk_bf16_f32 v77, v110, v111
    v_cvt_pk_bf16_f32 v78, v112, v113
    v_cvt_pk_bf16_f32 v79, v114, v115
    v_dot2_f32_bf16 v68, v76, s12, 0
    v_dot2_f32_bf16 v69, v76, v76, 0
    v_dot2_f32_bf16 v68, v77, s12, v68
    v_dot2_f32_bf16 v69, v77, v77, v69
    v_dot2_f32_bf16 v68, v78, s12, v68
    v_dot2_f32_bf16 v69, v78, v78, v69
    v_dot2_f32_bf16 v68, v79, s12, v68
    v_dot2_f32_bf16 v69, v79, v79, v69
    v_cvt_pk_bf16_f32 v117, v116, v117
    v_cvt_pk_bf16_f32 v119, v118, v119
    v_cvt_pk_bf16_f32 v121, v120, v121
    v_cvt_pk_bf16_f32 v123, v122, v123
    v_lshlrev_b32 v116, 16, v117
    v_and_b32 v117, 0xffff0000, v117
    v_lshlrev_b32 v118, 16, v119
    v_and_b32 v119, 0xffff0000, v119
    v_lshlrev_b32 v120, 16, v121
    v_and_b32 v121, 0xffff0000, v121
    v_lshlrev_b32 v122, 16, v123
    v_and_b32 v123, 0xffff0000, v123
    v_pk_add_f32 v[116:117], v[116:117], v[220:221]
    v_pk_add_f32 v[118:119], v[118:119], v[222:223]
    v_pk_add_f32 v[120:121], v[120:121], v[224:225]
    v_pk_add_f32 v[122:123], v[122:123], v[226:227]
    v_cvt_pk_bf16_f32 v80, v116, v117
    v_cvt_pk_bf16_f32 v81, v118, v119
    v_cvt_pk_bf16_f32 v82, v120, v121
    v_cvt_pk_bf16_f32 v83, v122, v123
    v_dot2_f32_bf16 v70, v80, s12, 0
    v_dot2_f32_bf16 v71, v80, v80, 0
    v_dot2_f32_bf16 v70, v81, s12, v70
    v_dot2_f32_bf16 v71, v81, v81, v71
    v_dot2_f32_bf16 v70, v82, s12, v70
    v_dot2_f32_bf16 v71, v82, v82, v71
    v_dot2_f32_bf16 v70, v83, s12, v70
    v_dot2_f32_bf16 v71, v83, v83, v71
    s_nop 1
    v_permlane32_swap_b32 v68, v70
    v_lshlrev_b32 v92, 16, v76
    v_permlane32_swap_b32 v69, v71
    v_and_b32 v93, 0xffff0000, v76
    v_add_f32 v68, v68, v70
    v_lshlrev_b32 v94, 16, v77
    v_add_f32 v69, v69, v71
    v_and_b32 v95, 0xffff0000, v77
    v_lshlrev_b32 v96, 16, v78
    v_permlane16_swap_b32 v68, v69
    v_and_b32 v97, 0xffff0000, v78
    v_add_f32 v68, v68, v69
    v_lshlrev_b32 v98, 16, v79
    s_nop 0
    v_add_f32_dpp v68, v68, v68 quad_perm:[1,0,3,2] row_mask:0xf bank_mask:0xf
    v_and_b32 v99, 0xffff0000, v79
    v_lshlrev_b32 v100, 16, v80
    v_add_f32_dpp v68, v68, v68 quad_perm:[2,3,0,1] row_mask:0xf bank_mask:0xf
    v_and_b32 v101, 0xffff0000, v80
    s_nop 0
    v_add_f32_dpp v68, v68, v68 row_half_mirror row_mask:0xf bank_mask:0xf
    v_lshlrev_b32 v102, 16, v81
    s_nop 0
    v_add_f32_dpp v68, v68, v68 row_mirror row_mask:0xf bank_mask:0xf
    v_and_b32 v103, 0xffff0000, v81
    v_lshlrev_b32 v104, 16, v82
    v_mov_b32 v67, v68
    v_and_b32 v105, 0xffff0000, v82
    s_nop 0
    v_permlane16_swap_b32 v68, v67
    v_lshlrev_b32 v106, 16, v83
    v_and_b32 v107, 0xffff0000, v83
    v_mul_f32 v68, 0x3b000000, v68
    v_mul_f32 v67, 0x3b000000, v67
    v_fma_f32 v67, -v68, v68, v67
    v_max_f32 v67, 0, v67
    v_cvt_pk_bf16_f32 v67, v67, v67
    v_and_b32 v67, 0xffff0000, v67
    v_add_f32 v67, 0x3727c5ac, v67
    v_cvt_pk_bf16_f32 v67, v67, v67
    v_and_b32 v67, 0xffff0000, v67
    v_sqrt_f32 v67, v67
    v_cvt_pk_bf16_f32 v68, v68, v68
    v_and_b32 v68, 0xffff0000, v68
    v_cvt_pk_bf16_f32 v67, v67, v67
    v_and_b32 v67, 0xffff0000, v67
    v_rcp_f32 v67, v67
    v_readlane_b32 s10, v68, 0
    v_readlane_b32 s11, v68, 32
    v_readlane_b32 s14, v67, 0
    v_readlane_b32 s15, v67, 32
    v_pk_add_f32 v[92:93], v[92:93], s[10:11] op_sel:[0,0] op_sel_hi:[1,0] neg_lo:[0,1] neg_hi:[0,1]
    v_pk_add_f32 v[94:95], v[94:95], s[10:11] op_sel:[0,0] op_sel_hi:[1,0] neg_lo:[0,1] neg_hi:[0,1]
    v_pk_add_f32 v[96:97], v[96:97], s[10:11] op_sel:[0,0] op_sel_hi:[1,0] neg_lo:[0,1] neg_hi:[0,1]
    v_pk_add_f32 v[98:99], v[98:99], s[10:11] op_sel:[0,0] op_sel_hi:[1,0] neg_lo:[0,1] neg_hi:[0,1]
    v_cvt_pk_bf16_f32 v93, v92, v93
    v_cvt_pk_bf16_f32 v95, v94, v95
    v_cvt_pk_bf16_f32 v97, v96, v97
    v_cvt_pk_bf16_f32 v99, v98, v99
    v_lshlrev_b32 v92, 16, v93
    v_and_b32 v93, 0xffff0000, v93
    v_lshlrev_b32 v94, 16, v95
    v_and_b32 v95, 0xffff0000, v95
    v_lshlrev_b32 v96, 16, v97
    v_and_b32 v97, 0xffff0000, v97
    v_lshlrev_b32 v98, 16, v99
    v_and_b32 v99, 0xffff0000, v99
    v_pk_mul_f32 v[92:93], v[92:93], s[14:15] op_sel:[0,0] op_sel_hi:[1,0]
    v_pk_mul_f32 v[94:95], v[94:95], s[14:15] op_sel:[0,0] op_sel_hi:[1,0]
    v_pk_mul_f32 v[96:97], v[96:97], s[14:15] op_sel:[0,0] op_sel_hi:[1,0]
    v_pk_mul_f32 v[98:99], v[98:99], s[14:15] op_sel:[0,0] op_sel_hi:[1,0]
    v_cvt_pk_bf16_f32 v84, v92, v93
    v_cvt_pk_bf16_f32 v85, v94, v95
    v_cvt_pk_bf16_f32 v86, v96, v97
    v_cvt_pk_bf16_f32 v87, v98, v99
    v_pk_add_f32 v[100:101], v[100:101], s[10:11] op_sel:[0,1] op_sel_hi:[1,1] neg_lo:[0,1] neg_hi:[0,1]
    v_pk_add_f32 v[102:103], v[102:103], s[10:11] op_sel:[0,1] op_sel_hi:[1,1] neg_lo:[0,1] neg_hi:[0,1]
    v_pk_add_f32 v[104:105], v[104:105], s[10:11] op_sel:[0,1] op_sel_hi:[1,1] neg_lo:[0,1] neg_hi:[0,1]
    v_pk_add_f32 v[106:107], v[106:107], s[10:11] op_sel:[0,1] op_sel_hi:[1,1] neg_lo:[0,1] neg_hi:[0,1]
    v_cvt_pk_bf16_f32 v101, v100, v101
    v_cvt_pk_bf16_f32 v103, v102, v103
    v_cvt_pk_bf16_f32 v105, v104, v105
    v_cvt_pk_bf16_f32 v107, v106, v107
    v_lshlrev_b32 v100, 16, v101
    v_and_b32 v101, 0xffff0000, v101
    v_lshlrev_b32 v102, 16, v103
    v_and_b32 v103, 0xffff0000, v103
    v_lshlrev_b32 v104, 16, v105
    v_and_b32 v105, 0xffff0000, v105
    v_lshlrev_b32 v106, 16, v107
    v_and_b32 v107, 0xffff0000, v107
    v_pk_mul_f32 v[100:101], v[100:101], s[14:15] op_sel:[0,1] op_sel_hi:[1,1]
    v_pk_mul_f32 v[102:103], v[102:103], s[14:15] op_sel:[0,1] op_sel_hi:[1,1]
    v_pk_mul_f32 v[104:105], v[104:105], s[14:15] op_sel:[0,1] op_sel_hi:[1,1]
    v_pk_mul_f32 v[106:107], v[106:107], s[14:15] op_sel:[0,1] op_sel_hi:[1,1]
    v_cvt_pk_bf16_f32 v88, v100, v101
    v_cvt_pk_bf16_f32 v89, v102, v103
    v_cvt_pk_bf16_f32 v90, v104, v105
    v_cvt_pk_bf16_f32 v91, v106, v107
    v_permlane32_swap_b32 v84, v88
    v_permlane32_swap_b32 v85, v89
    v_permlane32_swap_b32 v86, v90
    v_permlane32_swap_b32 v87, v91
    global_store_dwordx4 v239, v[84:87], s[62:63] offset:0 sc1
    global_store_dwordx4 v239, v[88:91], s[62:63] offset:2048 sc1
    v_mov_b32 v252, v14
    v_mov_b32 v20, -1
    v_mov_b32 v21, -1
    v_mov_b32 v22, -1
    v_mov_b32 v23, -1
    v_mov_b32 v24, s40
    v_mov_b32 v25, s40
    v_mov_b32 v26, s40
    v_mov_b32 v27, s40
    s_lshl_b32 s9, s3, 11
    s_add_u32 s9, s9, 140288
    v_add_u32 v252, s9, v14
    ds_write_b64 v252, v[76:77] offset:0
    ds_write_b64 v252, v[78:79] offset:512
    ds_write_b64 v252, v[80:81] offset:1024
    ds_write_b64 v252, v[82:83] offset:1536
    s_waitcnt lgkmcnt(0)
    v_bfe_u32 v5, v2, 2, 3
    v_lshlrev_b32 v3, 12, v5
    v_and_b32 v5, 3, v2
    v_lshl_add_u32 v3, v5, 5, v3
    v_lshrrev_b32 v5, 5, v2
    v_lshl_add_u32 v3, v5, 4, v3
    s_lshl_b32 s12, s36, 2
    s_add_u32 s12, s12, s3
    s_lshl_b32 s13, s12, 15
    s_add_u32 s13, s13, 8388608
    v_lshlrev_b32 v4, 4, v2
    s_add_u32 s4, s34, s13
    s_addc_u32 s5, s35, 0
    s_lshl_b32 s14, s12, 4
    s_add_u32 s14, s14, s37
    s_mul_i32 s13, s14, 9216
    s_add_u32 s13, s13, 10489856
    s_add_u32 s6, s34, s13
    s_addc_u32 s7, s35, 0
    s_add_u32 s10, s6, 4096
    s_addc_u32 s11, s7, 0
    s_lshl_b32 s14, s14, 9
    s_add_u32 s14, s14, 19922944
    s_add_u32 s42, s34, s14
    s_addc_u32 s43, s35, 0
    v_add_u32 v7, 65536, v4
    v_add_u32 v8, 131072, v4
    v_bfe_u32 v5, v2, 5, 1
    v_bfe_u32 v6, v2, 2, 2
    v_lshl_add_u32 v5, v5, 2, v6
    v_and_b32 v6, 3, v2
    v_lshlrev_b32 v6, 3, v6
    v_lshl_add_u32 v248, v5, 7, v6
    v_bfe_u32 v6, v2, 4, 1
    v_lshl_add_u32 v248, v6, 11, v248
    v_lshl_add_u32 v248, v6, 6, v248
    v_and_b32 v6, 8, v2
    v_lshl_add_u32 v248, v6, 2, v248
    v_xor_b32 v249, 32, v248
    v_xor_b32 v250, 64, v248
    v_xor_b32 v251, 96, v248
    s_sleep 20
    s_waitcnt vmcnt(0)
    v_mov_b32 v5, 163808
    v_mov_b32 v6, 1
    s_mov_b64 exec, 1
    ds_add_u32 v5, v6 offset:12
    s_mov_b64 exec, -1
    global_load_dwordx4 v[116:119], v3, s[4:5] offset:0 sc1
    global_load_dwordx4 v[120:123], v3, s[4:5] offset:128 sc1
    global_load_dwordx4 v[124:127], v3, s[4:5] offset:256 sc1
    global_load_dwordx4 v[128:131], v3, s[4:5] offset:384 sc1
    global_load_dwordx4 v[132:135], v3, s[4:5] offset:512 sc1
    global_load_dwordx4 v[136:139], v3, s[4:5] offset:640 sc1
    global_load_dwordx4 v[140:143], v3, s[4:5] offset:768 sc1
    global_load_dwordx4 v[144:147], v3, s[4:5] offset:896 sc1
    global_load_dwordx4 v[180:183], v3, s[4:5] offset:2048 sc1
    s_barrier
    ds_read_b64_tr_b16 v[28:29], v248 offset:0
    ds_read_b64_tr_b16 v[30:31], v248 offset:1024
    ds_read_b64_tr_b16 v[32:33], v249 offset:0
    ds_read_b64_tr_b16 v[34:35], v249 offset:1024
    ds_read_b64_tr_b16 v[36:37], v250 offset:0
    ds_read_b64_tr_b16 v[38:39], v250 offset:1024
    ds_read_b64_tr_b16 v[40:41], v251 offset:0
    ds_read_b64_tr_b16 v[42:43], v251 offset:1024
    ds_read_b64_tr_b16 v[44:45], v248 offset:4096
    ds_read_b64_tr_b16 v[46:47], v248 offset:5120
    s_waitcnt vmcnt(0)
    v_max3_u32 v5, v117, v119, v121
    v_max3_u32 v5, v5, v123, v125
    v_max3_u32 v5, v5, v127, v129
    v_max3_u32 v5, v5, v131, v133
    v_max3_u32 v5, v5, v135, v137
    v_max3_u32 v5, v5, v139, v141
    v_max3_u32 v5, v5, v143, v145
    v_max3_u32 v5, v5, v147, v181
    v_max_u32 v5, v5, v183
    v_cmp_le_u32 vcc, 0xffff0000, v5
    s_cbranch_vccnz Lpoll10
Lok11:
    ds_read_b64_tr_b16 v[48:49], v249 offset:4096
    ds_read_b64_tr_b16 v[50:51], v249 offset:5120
    global_load_dwordx4 v[148:151], v3, s[4:5] offset:1024 sc1
    s_waitcnt lgkmcnt(8)
    v_mfma_f32_32x32x16_bf16 v[52:67], v[28:31], v[116:119], 0
    ds_read_b64_tr_b16 v[28:29], v250 offset:4096
    ds_read_b64_tr_b16 v[30:31], v250 offset:5120
    v_mfma_f32_32x32x16_bf16 v[68:83], v[32:35], v[116:119], 0
    ds_read_b64_tr_b16 v[32:33], v251 offset:4096
    ds_read_b64_tr_b16 v[34:35], v251 offset:5120
    global_load_dwordx4 v[152:155], v3, s[4:5] offset:1152 sc1
    s_waitcnt lgkmcnt(8)
    v_mfma_f32_32x32x16_bf16 v[84:99], v[36:39], v[116:119], 0
    ds_read_b64_tr_b16 v[36:37], v248 offset:8192
    ds_read_b64_tr_b16 v[38:39], v248 offset:9216
    v_mfma_f32_32x32x16_bf16 v[100:115], v[40:43], v[116:119], 0
    ds_read_b64_tr_b16 v[40:41], v249 offset:8192
    ds_read_b64_tr_b16 v[42:43], v249 offset:9216
    global_load_dwordx4 v[156:159], v3, s[4:5] offset:1280 sc1
    s_waitcnt lgkmcnt(8)
    v_mfma_f32_32x32x16_bf16 v[52:67], v[44:47], v[120:123], v[52:67]
    ds_read_b64_tr_b16 v[44:45], v250 offset:8192
    ds_read_b64_tr_b16 v[46:47], v250 offset:9216
    v_mfma_f32_32x32x16_bf16 v[68:83], v[48:51], v[120:123], v[68:83]
    ds_read_b64_tr_b16 v[48:49], v251 offset:8192
    ds_read_b64_tr_b16 v[50:51], v251 offset:9216
    global_load_dwordx4 v[160:163], v3, s[4:5] offset:1408 sc1
    s_waitcnt lgkmcnt(8)
    v_mfma_f32_32x32x16_bf16 v[84:99], v[28:31], v[120:123], v[84:99]
    ds_read_b64_tr_b16 v[28:29], v248 offset:12288
    ds_read_b64_tr_b16 v[30:31], v248 offset:13312
    v_mfma_f32_32x32x16_bf16 v[100:115], v[32:35], v[120:123], v[100:115]
    ds_read_b64_tr_b16 v[32:33], v249 offset:12288
    ds_read_b64_tr_b16 v[34:35], v249 offset:13312
    global_load_dwordx4 v[164:167], v3, s[4:5] offset:1536 sc1
    s_waitcnt lgkmcnt(8)
    v_mfma_f32_32x32x16_bf16 v[52:67], v[36:39], v[124:127], v[52:67]
    ds_read_b64_tr_b16 v[36:37], v250 offset:12288
    ds_read_b64_tr_b16 v[38:39], v250 offset:13312
    v_mfma_f32_32x32x16_bf16 v[68:83], v[40:43], v[124:127], v[68:83]
    ds_read_b64_tr_b16 v[40:41], v251 offset:12288
    ds_read_b64_tr_b16 v[42:43], v251 offset:13312
    global_load_dwordx4 v[168:171], v3, s[4:5] offset:1664 sc1
    s_waitcnt lgkmcnt(8)
    v_mfma_f32_32x32x16_bf16 v[84:99], v[44:47], v[124:127], v[84:99]
    ds_read_b64_tr_b16 v[44:45], v248 offset:16384
    ds_read_b64_tr_b16 v[46:47], v248 offset:17408
    v_mfma_f32_32x32x16_bf16 v[100:115], v[48:51], v[124:127], v[100:115]
    ds_read_b64_tr_b16 v[48:49], v249 offset:16384
    ds_read_b64_tr_b16 v[50:51], v249 offset:17408
    global_load_dwordx4 v[172:175], v3, s[4:5] offset:1792 sc1
    s_waitcnt lgkmcnt(8)
    v_mfma_f32_32x32x16_bf16 v[52:67], v[28:31], v[128:131], v[52:67]
    ds_read_b64_tr_b16 v[28:29], v250 offset:16384
    ds_read_b64_tr_b16 v[30:31], v250 offset:17408
    v_mfma_f32_32x32x16_bf16 v[68:83], v[32:35], v[128:131], v[68:83]
    ds_read_b64_tr_b16 v[32:33], v251 offset:16384
    ds_read_b64_tr_b16 v[34:35], v251 offset:17408
    global_load_dwordx4 v[176:179], v3, s[4:5] offset:1920 sc1
    s_waitcnt lgkmcnt(8)
    v_mfma_f32_32x32x16_bf16 v[84:99], v[36:39], v[128:131], v[84:99]
    ds_read_b64_tr_b16 v[36:37], v248 offset:20480
    ds_read_b64_tr_b16 v[38:39], v248 offset:21504
    v_mfma_f32_32x32x16_bf16 v[100:115], v[40:43], v[128:131], v[100:115]
    ds_read_b64_tr_b16 v[40:41], v249 offset:20480
    ds_read_b64_tr_b16 v[42:43], v249 offset:21504
    global_load_dwordx4 v[184:187], v3, s[4:5] offset:2176 sc1
    s_waitcnt lgkmcnt(8)
    v_mfma_f32_32x32x16_bf16 v[52:67], v[44:47], v[132:135], v[52:67]
    ds_read_b64_tr_b16 v[44:45], v250 offset:20480
    ds_read_b64_tr_b16 v[46:47], v250 offset:21504
    v_mfma_f32_32x32x16_bf16 v[68:83], v[48:51], v[132:135], v[68:83]
    ds_read_b64_tr_b16 v[48:49], v251 offset:20480
    ds_read_b64_tr_b16 v[50:51], v251 offset:21504
    global_load_dwordx4 v[188:191], v3, s[4:5] offset:2304 sc1
    s_waitcnt lgkmcnt(8)
    v_mfma_f32_32x32x16_bf16 v[84:99], v[28:31], v[132:135], v[84:99]
    ds_read_b64_tr_b16 v[28:29], v248 offset:24576
    ds_read_b64_tr_b16 v[30:31], v248 offset:25600
    v_mfma_f32_32x32x16_bf16 v[100:115], v[32:35], v[132:135], v[100:115]
    ds_read_b64_tr_b16 v[32:33], v249 offset:24576
    ds_read_b64_tr_b16 v[34:35], v249 offset:25600
    global_load_dwordx4 v[192:195], v3, s[4:5] offset:2432 sc1
    s_waitcnt lgkmcnt(8)
    v_mfma_f32_32x32x16_bf16 v[52:67], v[36:39], v[136:139], v[52:67]
    ds_read_b64_tr_b16 v[36:37], v250 offset:24576
    ds_read_b64_tr_b16 v[38:39], v250 offset:25600
    v_mfma_f32_32x32x16_bf16 v[68:83], v[40:43], v[136:139], v[68:83]
    ds_read_b64_tr_b16 v[40:41], v251 offset:24576
    ds_read_b64_tr_b16 v[42:43], v251 offset:25600
    global_load_dwordx4 v[196:199], v3, s[4:5] offset:2560 sc1
    s_waitcnt lgkmcnt(8)
    v_mfma_f32_32x32x16_bf16 v[84:99], v[44:47], v[136:139], v[84:99]
    ds_read_b64_tr_b16 v[44:45], v248 offset:28672
    ds_read_b64_tr_b16 v[46:47], v248 offset:29696
    v_mfma_f32_32x32x16_bf16 v[100:115], v[48:51], v[136:139], v[100:115]
    ds_read_b64_tr_b16 v[48:49], v249 offset:28672
    ds_read_b64_tr_b16 v[50:51], v249 offset:29696
    global_load_dwordx4 v[200:203], v3, s[4:5] offset:2688 sc1
    s_waitcnt lgkmcnt(8)
    v_mfma_f32_32x32x16_bf16 v[52:67], v[28:31], v[140:143], v[52:67]
    ds_read_b64_tr_b16 v[28:29], v250 offset:28672
    ds_read_b64_tr_b16 v[30:31], v250 offset:29696
    v_mfma_f32_32x32x16_bf16 v[68:83], v[32:35], v[140:143], v[68:83]
    ds_read_b64_tr_b16 v[32:33], v251 offset:28672
    ds_read_b64_tr_b16 v[34:35], v251 offset:29696
    global_load_dwordx4 v[204:207], v3, s[4:5] offset:2816 sc1
    s_waitcnt lgkmcnt(8)
    v_mfma_f32_32x32x16_bf16 v[84:99], v[36:39], v[140:143], v[84:99]
    ds_read_b64_tr_b16 v[36:37], v248 offset:32768
    ds_read_b64_tr_b16 v[38:39], v248 offset:33792
    v_mfma_f32_32x32x16_bf16 v[100:115], v[40:43], v[140:143], v[100:115]
    ds_read_b64_tr_b16 v[40:41], v249 offset:32768
    ds_read_b64_tr_b16 v[42:43], v249 offset:33792
    global_load_dwordx4 v[208:211], v3, s[4:5] offset:2944 sc1
    s_waitcnt lgkmcnt(8)
    v_mfma_f32_32x32x16_bf16 v[52:67], v[44:47], v[144:147], v[52:67]
    ds_read_b64_tr_b16 v[44:45], v250 offset:32768
    ds_read_b64_tr_b16 v[46:47], v250 offset:33792
    v_mfma_f32_32x32x16_bf16 v[68:83], v[48:51], v[144:147], v[68:83]
    ds_read_b64_tr_b16 v[48:49], v251 offset:32768
    ds_read_b64_tr_b16 v[50:51], v251 offset:33792
    global_load_dwordx4 v[212:215], v3, s[4:5] offset:3072 sc1
    s_waitcnt lgkmcnt(8)
    v_mfma_f32_32x32x16_bf16 v[84:99], v[28:31], v[144:147], v[84:99]
    ds_read_b64_tr_b16 v[28:29], v248 offset:36864
    ds_read_b64_tr_b16 v[30:31], v248 offset:37888
    v_mfma_f32_32x32x16_bf16 v[100:115], v[32:35], v[144:147], v[100:115]
    ds_read_b64_tr_b16 v[32:33], v249 offset:36864
    ds_read_b64_tr_b16 v[34:35], v249 offset:37888
    global_load_dwordx4 v[216:219], v3, s[4:5] offset:3200 sc1
    s_waitcnt vmcnt(13)
    v_max3_u32 v5, v149, v151, v153
    v_max3_u32 v5, v5, v155, v157
    v_max3_u32 v5, v5, v159, v161
    v_max_u32 v5, v5, v163
    v_cmp_le_u32 vcc, 0xffff0000, v5
    s_cbranch_vccnz Lpoll12
Lok13:
    s_waitcnt lgkmcnt(8)
    v_mfma_f32_32x32x16_bf16 v[52:67], v[36:39], v[148:151], v[52:67]
    ds_read_b64_tr_b16 v[36:37], v250 offset:36864
    ds_read_b64_tr_b16 v[38:39], v250 offset:37888
    v_mfma_f32_32x32x16_bf16 v[68:83], v[40:43], v[148:151], v[68:83]
    ds_read_b64_tr_b16 v[40:41], v251 offset:36864
    ds_read_b64_tr_b16 v[42:43], v251 offset:37888
    global_load_dwordx4 v[220:223], v3, s[4:5] offset:3328 sc1
    s_waitcnt lgkmcnt(8)
    v_mfma_f32_32x32x16_bf16 v[84:99], v[44:47], v[148:151], v[84:99]
    ds_read_b64_tr_b16 v[44:45], v248 offset:40960
    ds_read_b64_tr_b16 v[46:47], v248 offset:41984
    v_mfma_f32_32x32x16_bf16 v[100:115], v[48:51], v[148:151], v[100:115]
    ds_read_b64_tr_b16 v[48:49], v249 offset:40960
    ds_read_b64_tr_b16 v[50:51], v249 offset:41984
    global_load_dwordx4 v[224:227], v3, s[4:5] offset:3456 sc1
    s_waitcnt lgkmcnt(8)
    v_mfma_f32_32x32x16_bf16 v[52:67], v[28:31], v[152:155], v[52:67]
    ds_read_b64_tr_b16 v[28:29], v250 offset:40960
    ds_read_b64_tr_b16 v[30:31], v250 offset:41984
    v_mfma_f32_32x32x16_bf16 v[68:83], v[32:35], v[152:155], v[68:83]
    ds_read_b64_tr_b16 v[32:33], v251 offset:40960
    ds_read_b64_tr_b16 v[34:35], v251 offset:41984
    global_load_dwordx4 v[228:231], v3, s[4:5] offset:3584 sc1
    s_waitcnt lgkmcnt(8)
    v_mfma_f32_32x32x16_bf16 v[84:99], v[36:39], v[152:155], v[84:99]
    ds_read_b64_tr_b16 v[36:37], v248 offset:45056
    ds_read_b64_tr_b16 v[38:39], v248 offset:46080
    v_mfma_f32_32x32x16_bf16 v[100:115], v[40:43], v[152:155], v[100:115]
    ds_read_b64_tr_b16 v[40:41], v249 offset:45056
    ds_read_b64_tr_b16 v[42:43], v249 offset:46080
    global_load_dwordx4 v[232:235], v3, s[4:5] offset:3712 sc1
    s_waitcnt lgkmcnt(8)
    v_mfma_f32_32x32x16_bf16 v[52:67], v[44:47], v[156:159], v[52:67]
    ds_read_b64_tr_b16 v[44:45], v250 offset:45056
    ds_read_b64_tr_b16 v[46:47], v250 offset:46080
    v_mfma_f32_32x32x16_bf16 v[68:83], v[48:51], v[156:159], v[68:83]
    ds_read_b64_tr_b16 v[48:49], v251 offset:45056
    ds_read_b64_tr_b16 v[50:51], v251 offset:46080
    global_load_dwordx4 v[236:239], v3, s[4:5] offset:3840 sc1
    s_waitcnt lgkmcnt(8)
    v_mfma_f32_32x32x16_bf16 v[84:99], v[28:31], v[156:159], v[84:99]
    ds_read_b64_tr_b16 v[28:29], v248 offset:49152
    ds_read_b64_tr_b16 v[30:31], v248 offset:50176
    v_mfma_f32_32x32x16_bf16 v[100:115], v[32:35], v[156:159], v[100:115]
    ds_read_b64_tr_b16 v[32:33], v248 offset:53248
    ds_read_b64_tr_b16 v[34:35], v248 offset:54272
    global_load_dwordx4 v[240:243], v3, s[4:5] offset:3968 sc1
    s_waitcnt lgkmcnt(8)
    v_mfma_f32_32x32x16_bf16 v[52:67], v[36:39], v[160:163], v[52:67]
    ds_read_b64_tr_b16 v[36:37], v248 offset:57344
    ds_read_b64_tr_b16 v[38:39], v248 offset:58368
    v_mfma_f32_32x32x16_bf16 v[68:83], v[40:43], v[160:163], v[68:83]
    ds_read_b64_tr_b16 v[40:41], v248 offset:61440
    ds_read_b64_tr_b16 v[42:43], v248 offset:62464
    s_waitcnt lgkmcnt(8)
    v_mfma_f32_32x32x16_bf16 v[84:99], v[44:47], v[160:163], v[84:99]
    v_add_u32 v248, 0x10000, v248
    ds_read_b64_tr_b16 v[44:45], v248 offset:0
    ds_read_b64_tr_b16 v[46:47], v248 offset:1024
    v_mfma_f32_32x32x16_bf16 v[100:115], v[48:51], v[160:163], v[100:115]
    s_barrier
    ds_read_b64_tr_b16 v[48:49], v248 offset:4096
    ds_read_b64_tr_b16 v[50:51], v248 offset:5120
    s_waitcnt vmcnt(15)
    v_max3_u32 v5, v165, v167, v169
    v_max3_u32 v5, v5, v171, v173
    v_max3_u32 v5, v5, v175, v177
    v_max_u32 v5, v5, v179
    v_cmp_le_u32 vcc, 0xffff0000, v5
    s_cbranch_vccnz Lpoll14
Lok15:
    s_waitcnt lgkmcnt(8)
    v_mfma_f32_32x32x16_bf16 v[52:67], v[28:31], v[164:167], v[52:67]
    ds_read_b64_tr_b16 v[28:29], v248 offset:8192
    ds_read_b64_tr_b16 v[30:31], v248 offset:9216
    v_mfma_f32_32x32x16_bf16 v[52:67], v[32:35], v[168:171], v[52:67]
    ds_read_b64_tr_b16 v[32:33], v248 offset:12288
    ds_read_b64_tr_b16 v[34:35], v248 offset:13312
    s_waitcnt lgkmcnt(8)
    v_mfma_f32_32x32x16_bf16 v[52:67], v[36:39], v[172:175], v[52:67]
    ds_read_b64_tr_b16 v[36:37], v248 offset:16384
    ds_read_b64_tr_b16 v[38:39], v248 offset:17408
    v_mfma_f32_32x32x16_bf16 v[52:67], v[40:43], v[176:179], v[52:67]
    ds_read_b64_tr_b16 v[40:41], v248 offset:20480
    ds_read_b64_tr_b16 v[42:43], v248 offset:21504
    s_waitcnt lgkmcnt(8)
    v_mfma_f32_32x32x16_bf16 v[52:67], v[44:47], v[180:183], v[52:67]
    ds_read_b64_tr_b16 v[44:45], v248 offset:24576
    ds_read_b64_tr_b16 v[46:47], v248 offset:25600
    s_waitcnt vmcnt(12)
    v_max3_u32 v5, v185, v187, v189
    v_max3_u32 v5, v5, v191, v193
    v_max_u32 v5, v5, v195
    v_cmp_le_u32 vcc, 0xffff0000, v5
    s_cbranch_vccnz Lpoll16
Lok17:
    s_nop 0
    v_mfma_f32_32x32x16_bf16 v[52:67], v[48:51], v[184:187], v[52:67]
    ds_read_b64_tr_b16 v[48:49], v248 offset:28672
    ds_read_b64_tr_b16 v[50:51], v248 offset:29696
    s_waitcnt lgkmcnt(8)
    v_mfma_f32_32x32x16_bf16 v[52:67], v[28:31], v[188:191], v[52:67]
    ds_read_b64_tr_b16 v[28:29], v248 offset:32768
    ds_read_b64_tr_b16 v[30:31], v248 offset:33792
    v_mfma_f32_32x32x16_bf16 v[52:67], v[32:35], v[192:195], v[52:67]
    ds_read_b64_tr_b16 v[32:33], v248 offset:36864
    ds_read_b64_tr_b16 v[34:35], v248 offset:37888
    s_waitcnt vmcnt(8)
    v_max3_u32 v5, v197, v199, v201
    v_max3_u32 v5, v5, v203, v205
    v_max3_u32 v5, v5, v207, v209
    v_max_u32 v5, v5, v211
    v_cmp_le_u32 vcc, 0xffff0000, v5
    s_cbranch_vccnz Lpoll18
Lok19:
    s_waitcnt lgkmcnt(8)
    v_mfma_f32_32x32x16_bf16 v[52:67], v[36:39], v[196:199], v[52:67]
    ds_read_b64_tr_b16 v[36:37], v248 offset:40960
    ds_read_b64_tr_b16 v[38:39], v248 offset:41984
    v_mfma_f32_32x32x16_bf16 v[52:67], v[40:43], v[200:203], v[52:67]
    ds_read_b64_tr_b16 v[40:41], v248 offset:45056
    ds_read_b64_tr_b16 v[42:43], v248 offset:46080
    s_waitcnt lgkmcnt(8)
    v_mfma_f32_32x32x16_bf16 v[52:67], v[44:47], v[204:207], v[52:67]
    ds_read_b64_tr_b16 v[44:45], v248 offset:49152
    ds_read_b64_tr_b16 v[46:47], v248 offset:50176
    v_mfma_f32_32x32x16_bf16 v[52:67], v[48:51], v[208:211], v[52:67]
    ds_read_b64_tr_b16 v[48:49], v248 offset:53248
    ds_read_b64_tr_b16 v[50:51], v248 offset:54272
    s_waitcnt vmcnt(4)
    v_max3_u32 v5, v213, v215, v217
    v_max3_u32 v5, v5, v219, v221
    v_max3_u32 v5, v5, v223, v225
    v_max_u32 v5, v5, v227
    v_cmp_le_u32 vcc, 0xffff0000, v5
    s_cbranch_vccnz Lpoll20
Lok21:
    s_waitcnt lgkmcnt(8)
    v_mfma_f32_32x32x16_bf16 v[52:67], v[28:31], v[212:215], v[52:67]
    v_mov_b32 v245, s40
    v_mov_b32 v247, s40
    ds_read_b64_tr_b16 v[28:29], v248 offset:57344
    ds_read_b64_tr_b16 v[30:31], v248 offset:58368
    v_mfma_f32_32x32x16_bf16 v[52:67], v[32:35], v[216:219], v[52:67]
    ds_read_b64_tr_b16 v[32:33], v248 offset:61440
    ds_read_b64_tr_b16 v[34:35], v248 offset:62464
    s_waitcnt lgkmcnt(8)
    v_mfma_f32_32x32x16_bf16 v[52:67], v[36:39], v[220:223], v[52:67]
    ds_read_b64_tr_b16 v[36:37], v249 offset:49152
    ds_read_b64_tr_b16 v[38:39], v249 offset:50176
    v_mfma_f32_32x32x16_bf16 v[52:67], v[40:43], v[224:227], v[52:67]
    ds_read_b64_tr_b16 v[40:41], v249 offset:53248
    ds_read_b64_tr_b16 v[42:43], v249 offset:54272
    s_waitcnt vmcnt(0)
    v_max3_u32 v5, v229, v231, v233
    v_max3_u32 v5, v5, v235, v237
    v_max3_u32 v5, v5, v239, v241
    v_max_u32 v5, v5, v243
    v_cmp_le_u32 vcc, 0xffff0000, v5
    s_cbranch_vccnz Lpoll22
Lok23:
    s_waitcnt lgkmcnt(8)
    v_mfma_f32_32x32x16_bf16 v[52:67], v[44:47], v[228:231], v[52:67]
    ds_read_b64_tr_b16 v[44:45], v249 offset:57344
    ds_read_b64_tr_b16 v[46:47], v249 offset:58368
    v_mfma_f32_32x32x16_bf16 v[52:67], v[48:51], v[232:235], v[52:67]
    ds_read_b64_tr_b16 v[48:49], v249 offset:61440
    ds_read_b64_tr_b16 v[50:51], v249 offset:62464
    s_waitcnt lgkmcnt(8)
    v_mfma_f32_32x32x16_bf16 v[52:67], v[28:31], v[236:239], v[52:67]
    v_add_u32 v249, 0x10000, v249
    ds_read_b64_tr_b16 v[28:29], v249 offset:0
    ds_read_b64_tr_b16 v[30:31], v249 offset:1024
    v_mfma_f32_32x32x16_bf16 v[52:67], v[32:35], v[240:243], v[52:67]
    ds_read_b64_tr_b16 v[32:33], v249 offset:4096
    ds_read_b64_tr_b16 v[34:35], v249 offset:5120
    s_waitcnt lgkmcnt(8)
    v_mfma_f32_32x32x16_bf16 v[68:83], v[36:39], v[164:167], v[68:83]
    ds_read_b64_tr_b16 v[36:37], v249 offset:8192
    ds_read_b64_tr_b16 v[38:39], v249 offset:9216
    v_mfma_f32_32x32x16_bf16 v[68:83], v[40:43], v[168:171], v[68:83]
    s_nop 4
    v_mul_f32 v9, 0xbfb8aa3b, v52
    v_mul_f32 v10, 0xbfb8aa3b, v53
    v_mul_f32 v11, 0xbfb8aa3b, v54
    ds_read_b64_tr_b16 v[40:41], v249 offset:12288
    ds_read_b64_tr_b16 v[42:43], v249 offset:13312
    s_waitcnt lgkmcnt(8)
    v_mfma_f32_32x32x16_bf16 v[68:83], v[44:47], v[172:175], v[68:83]
    v_mul_f32 v12, 0xbfb8aa3b, v55
    v_exp_f32 v9, v9
    ds_read_b64_tr_b16 v[44:45], v249 offset:16384
    ds_read_b64_tr_b16 v[46:47], v249 offset:17408
    v_mfma_f32_32x32x16_bf16 v[68:83], v[48:51], v[176:179], v[68:83]
    v_exp_f32 v10, v10
    v_exp_f32 v11, v11
    ds_read_b64_tr_b16 v[48:49], v249 offset:20480
    ds_read_b64_tr_b16 v[50:51], v249 offset:21504
    s_waitcnt lgkmcnt(8)
    v_mfma_f32_32x32x16_bf16 v[68:83], v[28:31], v[180:183], v[68:83]
    v_exp_f32 v12, v12
    v_add_f32 v9, 1.0, v9
    ds_read_b64_tr_b16 v[28:29], v249 offset:24576
    ds_read_b64_tr_b16 v[30:31], v249 offset:25600
    v_mfma_f32_32x32x16_bf16 v[68:83], v[32:35], v[184:187], v[68:83]
    v_add_f32 v10, 1.0, v10
    v_add_f32 v11, 1.0, v11
    v_add_f32 v12, 1.0, v12
    ds_read_b64_tr_b16 v[32:33], v249 offset:28672
    ds_read_b64_tr_b16 v[34:35], v249 offset:29696
    s_waitcnt lgkmcnt(8)
    v_mfma_f32_32x32x16_bf16 v[68:83], v[36:39], v[188:191], v[68:83]
    v_rcp_f32 v9, v9
    v_rcp_f32 v10, v10
    ds_read_b64_tr_b16 v[36:37], v249 offset:32768
    ds_read_b64_tr_b16 v[38:39], v249 offset:33792
    v_mfma_f32_32x32x16_bf16 v[68:83], v[40:43], v[192:195], v[68:83]
    v_rcp_f32 v11, v11
    v_rcp_f32 v12, v12
    ds_read_b64_tr_b16 v[40:41], v249 offset:36864
    ds_read_b64_tr_b16 v[42:43], v249 offset:37888
    s_waitcnt lgkmcnt(8)
    v_mfma_f32_32x32x16_bf16 v[68:83], v[44:47], v[196:199], v[68:83]
    v_mul_f32 v9, v9, v60
    v_mul_f32 v10, v10, v61
    v_mul_f32 v11, v11, v62
    ds_read_b64_tr_b16 v[44:45], v249 offset:40960
    ds_read_b64_tr_b16 v[46:47], v249 offset:41984
    v_mfma_f32_32x32x16_bf16 v[68:83], v[48:51], v[200:203], v[68:83]
    v_mul_f32 v12, v12, v63
    v_cvt_pk_bf16_f32 v20, v9, v10
    v_cvt_pk_bf16_f32 v21, v11, v12
    ds_read_b64_tr_b16 v[48:49], v249 offset:45056
    ds_read_b64_tr_b16 v[50:51], v249 offset:46080
    s_waitcnt lgkmcnt(8)
    v_mfma_f32_32x32x16_bf16 v[68:83], v[28:31], v[204:207], v[68:83]
    v_mul_f32 v13, 0xbfb8aa3b, v56
    v_mul_f32 v14, 0xbfb8aa3b, v57
    v_mul_f32 v15, 0xbfb8aa3b, v58
    ds_read_b64_tr_b16 v[28:29], v249 offset:49152
    ds_read_b64_tr_b16 v[30:31], v249 offset:50176
    v_mfma_f32_32x32x16_bf16 v[68:83], v[32:35], v[208:211], v[68:83]
    v_mul_f32 v16, 0xbfb8aa3b, v59
    v_exp_f32 v13, v13
    ds_read_b64_tr_b16 v[32:33], v249 offset:53248
    ds_read_b64_tr_b16 v[34:35], v249 offset:54272
    s_waitcnt lgkmcnt(8)
    v_mfma_f32_32x32x16_bf16 v[68:83], v[36:39], v[212:215], v[68:83]
    v_exp_f32 v14, v14
    v_exp_f32 v15, v15
    ds_read_b64_tr_b16 v[36:37], v249 offset:57344
    ds_read_b64_tr_b16 v[38:39], v249 offset:58368
    v_mfma_f32_32x32x16_bf16 v[68:83], v[40:43], v[216:219], v[68:83]
    v_exp_f32 v16, v16
    v_add_f32 v13, 1.0, v13
    ds_read_b64_tr_b16 v[40:41], v249 offset:61440
    ds_read_b64_tr_b16 v[42:43], v249 offset:62464
    s_waitcnt lgkmcnt(8)
    v_mfma_f32_32x32x16_bf16 v[68:83], v[44:47], v[220:223], v[68:83]
    v_add_f32 v14, 1.0, v14
    v_add_f32 v15, 1.0, v15
    v_add_f32 v16, 1.0, v16
    ds_read_b64_tr_b16 v[44:45], v250 offset:49152
    ds_read_b64_tr_b16 v[46:47], v250 offset:50176
    v_mfma_f32_32x32x16_bf16 v[68:83], v[48:51], v[224:227], v[68:83]
    v_rcp_f32 v13, v13
    v_rcp_f32 v14, v14
    ds_read_b64_tr_b16 v[48:49], v250 offset:53248
    ds_read_b64_tr_b16 v[50:51], v250 offset:54272
    s_waitcnt lgkmcnt(8)
    v_mfma_f32_32x32x16_bf16 v[68:83], v[28:31], v[228:231], v[68:83]
    v_rcp_f32 v15, v15
    v_rcp_f32 v16, v16
    ds_read_b64_tr_b16 v[28:29], v250 offset:57344
    ds_read_b64_tr_b16 v[30:31], v250 offset:58368
    v_mfma_f32_32x32x16_bf16 v[68:83], v[32:35], v[232:235], v[68:83]
    v_mul_f32 v13, v13, v64
    v_mul_f32 v14, v14, v65
    v_mul_f32 v15, v15, v66
    ds_read_b64_tr_b16 v[32:33], v250 offset:61440
    ds_read_b64_tr_b16 v[34:35], v250 offset:62464
    s_waitcnt lgkmcnt(8)
    v_mfma_f32_32x32x16_bf16 v[68:83], v[36:39], v[236:239], v[68:83]
    v_mul_f32 v16, v16, v67
    v_cvt_pk_bf16_f32 v22, v13, v14
    v_cvt_pk_bf16_f32 v23, v15, v16
    v_add_u32 v250, 0x10000, v250
    ds_read_b64_tr_b16 v[36:37], v250 offset:0
    ds_read_b64_tr_b16 v[38:39], v250 offset:1024
    v_mfma_f32_32x32x16_bf16 v[68:83], v[40:43], v[240:243], v[68:83]
    global_store_dwordx4 v4, v[20:23], s[6:7] offset:-4096 sc1
    ds_read_b64_tr_b16 v[40:41], v250 offset:4096
    ds_read_b64_tr_b16 v[42:43], v250 offset:5120
    s_waitcnt lgkmcnt(8)
    v_mfma_f32_32x32x16_bf16 v[84:99], v[44:47], v[164:167], v[84:99]
    ds_read_b64_tr_b16 v[44:45], v250 offset:8192
    ds_read_b64_tr_b16 v[46:47], v250 offset:9216
    v_mfma_f32_32x32x16_bf16 v[84:99], v[48:51], v[168:171], v[84:99]
    s_nop 3
    v_mul_f32 v9, 0xbfb8aa3b, v68
    v_mul_f32 v10, 0xbfb8aa3b, v69
    v_mul_f32 v11, 0xbfb8aa3b, v70
    ds_read_b64_tr_b16 v[48:49], v250 offset:12288
    ds_read_b64_tr_b16 v[50:51], v250 offset:13312
    s_waitcnt lgkmcnt(8)
    v_mfma_f32_32x32x16_bf16 v[84:99], v[28:31], v[172:175], v[84:99]
    v_mul_f32 v12, 0xbfb8aa3b, v71
    v_exp_f32 v9, v9
    ds_read_b64_tr_b16 v[28:29], v250 offset:16384
    ds_read_b64_tr_b16 v[30:31], v250 offset:17408
    v_mfma_f32_32x32x16_bf16 v[84:99], v[32:35], v[176:179], v[84:99]
    v_exp_f32 v10, v10
    v_exp_f32 v11, v11
    ds_read_b64_tr_b16 v[32:33], v250 offset:20480
    ds_read_b64_tr_b16 v[34:35], v250 offset:21504
    s_waitcnt lgkmcnt(8)
    v_mfma_f32_32x32x16_bf16 v[84:99], v[36:39], v[180:183], v[84:99]
    v_exp_f32 v12, v12
    v_add_f32 v9, 1.0, v9
    ds_read_b64_tr_b16 v[36:37], v250 offset:24576
    ds_read_b64_tr_b16 v[38:39], v250 offset:25600
    v_mfma_f32_32x32x16_bf16 v[84:99], v[40:43], v[184:187], v[84:99]
    v_add_f32 v10, 1.0, v10
    v_add_f32 v11, 1.0, v11
    v_add_f32 v12, 1.0, v12
    ds_read_b64_tr_b16 v[40:41], v250 offset:28672
    ds_read_b64_tr_b16 v[42:43], v250 offset:29696
    s_waitcnt lgkmcnt(8)
    v_mfma_f32_32x32x16_bf16 v[84:99], v[44:47], v[188:191], v[84:99]
    v_rcp_f32 v9, v9
    v_rcp_f32 v10, v10
    ds_read_b64_tr_b16 v[44:45], v250 offset:32768
    ds_read_b64_tr_b16 v[46:47], v250 offset:33792
    v_mfma_f32_32x32x16_bf16 v[84:99], v[48:51], v[192:195], v[84:99]
    v_rcp_f32 v11, v11
    v_rcp_f32 v12, v12
    ds_read_b64_tr_b16 v[48:49], v250 offset:36864
    ds_read_b64_tr_b16 v[50:51], v250 offset:37888
    s_waitcnt lgkmcnt(8)
    v_mfma_f32_32x32x16_bf16 v[84:99], v[28:31], v[196:199], v[84:99]
    v_mul_f32 v9, v9, v76
    v_mul_f32 v10, v10, v77
    v_mul_f32 v11, v11, v78
    ds_read_b64_tr_b16 v[28:29], v250 offset:40960
    ds_read_b64_tr_b16 v[30:31], v250 offset:41984
    v_mfma_f32_32x32x16_bf16 v[84:99], v[32:35], v[200:203], v[84:99]
    v_mul_f32 v12, v12, v79
    v_cvt_pk_bf16_f32 v24, v9, v10
    v_cvt_pk_bf16_f32 v25, v11, v12
    ds_read_b64_tr_b16 v[32:33], v250 offset:45056
    ds_read_b64_tr_b16 v[34:35], v250 offset:46080
    s_waitcnt lgkmcnt(8)
    v_mfma_f32_32x32x16_bf16 v[84:99], v[36:39], v[204:207], v[84:99]
    v_mul_f32 v13, 0xbfb8aa3b, v72
    v_mul_f32 v14, 0xbfb8aa3b, v73
    v_mul_f32 v15, 0xbfb8aa3b, v74
    ds_read_b64_tr_b16 v[36:37], v250 offset:49152
    ds_read_b64_tr_b16 v[38:39], v250 offset:50176
    v_mfma_f32_32x32x16_bf16 v[84:99], v[40:43], v[208:211], v[84:99]
    v_mul_f32 v16, 0xbfb8aa3b, v75
    v_exp_f32 v13, v13
    ds_read_b64_tr_b16 v[40:41], v250 offset:53248
    ds_read_b64_tr_b16 v[42:43], v250 offset:54272
    s_waitcnt lgkmcnt(8)
    v_mfma_f32_32x32x16_bf16 v[84:99], v[44:47], v[212:215], v[84:99]
    v_exp_f32 v14, v14
    v_exp_f32 v15, v15
    ds_read_b64_tr_b16 v[44:45], v250 offset:57344
    ds_read_b64_tr_b16 v[46:47], v250 offset:58368
    v_mfma_f32_32x32x16_bf16 v[84:99], v[48:51], v[216:219], v[84:99]
    v_exp_f32 v16, v16
    v_add_f32 v13, 1.0, v13
    ds_read_b64_tr_b16 v[48:49], v250 offset:61440
    ds_read_b64_tr_b16 v[50:51], v250 offset:62464
    s_waitcnt lgkmcnt(8)
    v_mfma_f32_32x32x16_bf16 v[84:99], v[28:31], v[220:223], v[84:99]
    v_add_f32 v14, 1.0, v14
    v_add_f32 v15, 1.0, v15
    v_add_f32 v16, 1.0, v16
    ds_read_b64_tr_b16 v[28:29], v251 offset:49152
    ds_read_b64_tr_b16 v[30:31], v251 offset:50176
    v_mfma_f32_32x32x16_bf16 v[84:99], v[32:35], v[224:227], v[84:99]
    v_rcp_f32 v13, v13
    v_rcp_f32 v14, v14
    ds_read_b64_tr_b16 v[32:33], v251 offset:53248
    ds_read_b64_tr_b16 v[34:35], v251 offset:54272
    s_waitcnt lgkmcnt(8)
    v_mfma_f32_32x32x16_bf16 v[84:99], v[36:39], v[228:231], v[84:99]
    v_rcp_f32 v15, v15
    v_rcp_f32 v16, v16
    ds_read_b64_tr_b16 v[36:37], v251 offset:57344
    ds_read_b64_tr_b16 v[38:39], v251 offset:58368
    v_mfma_f32_32x32x16_bf16 v[84:99], v[40:43], v[232:235], v[84:99]
    v_mul_f32 v13, v13, v80
    v_mul_f32 v14, v14, v81
    v_mul_f32 v15, v15, v82
    ds_read_b64_tr_b16 v[40:41], v251 offset:61440
    ds_read_b64_tr_b16 v[42:43], v251 offset:62464
    s_waitcnt lgkmcnt(8)
    v_mfma_f32_32x32x16_bf16 v[84:99], v[44:47], v[236:239], v[84:99]
    v_mul_f32 v16, v16, v83
    v_cvt_pk_bf16_f32 v26, v13, v14
    v_cvt_pk_bf16_f32 v27, v15, v16
    v_add_u32 v251, 0x10000, v251
    ds_read_b64_tr_b16 v[44:45], v251 offset:0
    ds_read_b64_tr_b16 v[46:47], v251 offset:1024
    v_mfma_f32_32x32x16_bf16 v[84:99], v[48:51], v[240:243], v[84:99]
    global_store_dwordx4 v4, v[24:27], s[6:7] offset:-3072 sc1
    ds_read_b64_tr_b16 v[48:49], v251 offset:4096
    ds_read_b64_tr_b16 v[50:51], v251 offset:5120
    s_waitcnt lgkmcnt(8)
    v_mfma_f32_32x32x16_bf16 v[100:115], v[28:31], v[164:167], v[100:115]
    ds_read_b64_tr_b16 v[28:29], v251 offset:8192
    ds_read_b64_tr_b16 v[30:31], v251 offset:9216
    v_mfma_f32_32x32x16_bf16 v[100:115], v[32:35], v[168:171], v[100:115]
    s_nop 3
    v_mul_f32 v9, 0xbfb8aa3b, v84
    v_mul_f32 v10, 0xbfb8aa3b, v85
    v_mul_f32 v11, 0xbfb8aa3b, v86
    ds_read_b64_tr_b16 v[32:33], v251 offset:12288
    ds_read_b64_tr_b16 v[34:35], v251 offset:13312
    s_waitcnt lgkmcnt(8)
    v_mfma_f32_32x32x16_bf16 v[100:115], v[36:39], v[172:175], v[100:115]
    v_mul_f32 v12, 0xbfb8aa3b, v87
    v_exp_f32 v9, v9
    ds_read_b64_tr_b16 v[36:37], v251 offset:16384
    ds_read_b64_tr_b16 v[38:39], v251 offset:17408
    v_mfma_f32_32x32x16_bf16 v[100:115], v[40:43], v[176:179], v[100:115]
    v_exp_f32 v10, v10
    v_exp_f32 v11, v11
    ds_read_b64_tr_b16 v[40:41], v251 offset:20480
    ds_read_b64_tr_b16 v[42:43], v251 offset:21504
    s_waitcnt lgkmcnt(8)
    v_mfma_f32_32x32x16_bf16 v[100:115], v[44:47], v[180:183], v[100:115]
    v_exp_f32 v12, v12
    v_add_f32 v9, 1.0, v9
    ds_read_b64_tr_b16 v[44:45], v251 offset:24576
    ds_read_b64_tr_b16 v[46:47], v251 offset:25600
    v_mfma_f32_32x32x16_bf16 v[100:115], v[48:51], v[184:187], v[100:115]
    v_add_f32 v10, 1.0, v10
    v_add_f32 v11, 1.0, v11
    v_add_f32 v12, 1.0, v12
    ds_read_b64_tr_b16 v[48:49], v251 offset:28672
    ds_read_b64_tr_b16 v[50:51], v251 offset:29696
    s_waitcnt lgkmcnt(8)
    v_mfma_f32_32x32x16_bf16 v[100:115], v[28:31], v[188:191], v[100:115]
    v_rcp_f32 v9, v9
    v_rcp_f32 v10, v10
    ds_read_b64_tr_b16 v[28:29], v251 offset:32768
    ds_read_b64_tr_b16 v[30:31], v251 offset:33792
    v_mfma_f32_32x32x16_bf16 v[100:115], v[32:35], v[192:195], v[100:115]
    v_rcp_f32 v11, v11
    v_rcp_f32 v12, v12
    ds_read_b64_tr_b16 v[32:33], v251 offset:36864
    ds_read_b64_tr_b16 v[34:35], v251 offset:37888
    s_waitcnt lgkmcnt(8)
    v_mfma_f32_32x32x16_bf16 v[100:115], v[36:39], v[196:199], v[100:115]
    v_mul_f32 v9, v9, v92
    v_mul_f32 v10, v10, v93
    v_mul_f32 v11, v11, v94
    ds_read_b64_tr_b16 v[36:37], v251 offset:40960
    ds_read_b64_tr_b16 v[38:39], v251 offset:41984
    v_mfma_f32_32x32x16_bf16 v[100:115], v[40:43], v[200:203], v[100:115]
    v_mul_f32 v12, v12, v95
    v_cvt_pk_bf16_f32 v20, v9, v10
    v_cvt_pk_bf16_f32 v21, v11, v12
    ds_read_b64_tr_b16 v[40:41], v251 offset:45056
    ds_read_b64_tr_b16 v[42:43], v251 offset:46080
    s_waitcnt lgkmcnt(8)
    v_mfma_f32_32x32x16_bf16 v[100:115], v[44:47], v[204:207], v[100:115]
    v_mul_f32 v13, 0xbfb8aa3b, v88
    v_mul_f32 v14, 0xbfb8aa3b, v89
    v_mul_f32 v15, 0xbfb8aa3b, v90
    ds_read_b64_tr_b16 v[44:45], v251 offset:49152
    ds_read_b64_tr_b16 v[46:47], v251 offset:50176
    v_mfma_f32_32x32x16_bf16 v[100:115], v[48:51], v[208:211], v[100:115]
    v_mul_f32 v16, 0xbfb8aa3b, v91
    v_exp_f32 v13, v13
    s_barrier
    ds_read_b64_tr_b16 v[48:49], v251 offset:53248
    ds_read_b64_tr_b16 v[50:51], v251 offset:54272
    s_waitcnt lgkmcnt(8)
    v_mfma_f32_32x32x16_bf16 v[100:115], v[28:31], v[212:215], v[100:115]
    v_exp_f32 v14, v14
    v_exp_f32 v15, v15
    ds_read_b64_tr_b16 v[28:29], v251 offset:57344
    ds_read_b64_tr_b16 v[30:31], v251 offset:58368
    v_mfma_f32_32x32x16_bf16 v[100:115], v[32:35], v[216:219], v[100:115]
    v_exp_f32 v16, v16
    v_add_f32 v13, 1.0, v13
    ds_read_b64_tr_b16 v[32:33], v251 offset:61440
    ds_read_b64_tr_b16 v[34:35], v251 offset:62464
    s_waitcnt lgkmcnt(8)
    v_mfma_f32_32x32x16_bf16 v[100:115], v[36:39], v[220:223], v[100:115]
    v_add_f32 v14, 1.0, v14
    v_add_f32 v15, 1.0, v15
    v_add_f32 v16, 1.0, v16
    ds_read_b128 v[36:39], v8 offset:0
    v_mfma_f32_32x32x16_bf16 v[100:115], v[40:43], v[224:227], v[100:115]
    v_rcp_f32 v13, v13
    v_rcp_f32 v14, v14
    ds_read_b128 v[40:43], v8 offset:4096
    s_waitcnt lgkmcnt(6)
    v_mfma_f32_32x32x16_bf16 v[100:115], v[44:47], v[228:231], v[100:115]
    v_rcp_f32 v15, v15
    v_rcp_f32 v16, v16
    ds_read_b128 v[44:47], v8 offset:8192
    v_mfma_f32_32x32x16_bf16 v[100:115], v[48:51], v[232:235], v[100:115]
    v_mul_f32 v13, v13, v96
    v_mul_f32 v14, v14, v97
    v_mul_f32 v15, v15, v98
    s_waitcnt vmcnt(0)
    s_mov_b64 exec, 0xff
    global_store_dwordx4 v4, v[244:247], s[42:43] offset:0 sc1
    s_mov_b64 exec, -1
    v_mov_b32 v5, 163808
    v_mov_b32 v6, 1
    s_mov_b64 exec, 1
    ds_add_u32 v5, v6 offset:16
    s_mov_b64 exec, -1
    ds_read_b128 v[48:51], v8 offset:12288
    s_waitcnt lgkmcnt(4)
    v_mfma_f32_32x32x16_bf16 v[100:115], v[28:31], v[236:239], v[100:115]
    v_mul_f32 v16, v16, v99
    v_cvt_pk_bf16_f32 v22, v13, v14
    v_cvt_pk_bf16_f32 v23, v15, v16
    ds_read_b128 v[28:31], v8 offset:1024
    v_mfma_f32_32x32x16_bf16 v[100:115], v[32:35], v[240:243], v[100:115]
    global_store_dwordx4 v4, v[20:23], s[6:7] offset:-2048 sc1
    ds_read_b128 v[32:35], v8 offset:5120
    s_waitcnt lgkmcnt(4)
    v_mfma_f32_32x32x16_bf16 v[52:67], v[36:39], v[116:119], 0
    ds_read_b128 v[36:39], v8 offset:9216
    v_mfma_f32_32x32x16_bf16 v[52:67], v[40:43], v[120:123], v[52:67]
    s_nop 5
    v_mul_f32 v9, 0xbfb8aa3b, v100
    v_mul_f32 v10, 0xbfb8aa3b, v101
    v_mul_f32 v11, 0xbfb8aa3b, v102
    ds_read_b128 v[40:43], v8 offset:13312
    s_waitcnt lgkmcnt(4)
    v_mfma_f32_32x32x16_bf16 v[52:67], v[44:47], v[124:127], v[52:67]
    v_mul_f32 v12, 0xbfb8aa3b, v103
    v_exp_f32 v9, v9
    ds_read_b128 v[44:47], v8 offset:2048
    v_mfma_f32_32x32x16_bf16 v[52:67], v[48:51], v[128:131], v[52:67]
    v_exp_f32 v10, v10
    v_exp_f32 v11, v11
    ds_read_b128 v[48:51], v8 offset:6144
    s_waitcnt lgkmcnt(4)
    v_mfma_f32_32x32x16_bf16 v[52:67], v[28:31], v[132:135], v[52:67]
    v_exp_f32 v12, v12
    v_add_f32 v9, 1.0, v9
    ds_read_b128 v[28:31], v8 offset:10240
    v_mfma_f32_32x32x16_bf16 v[52:67], v[32:35], v[136:139], v[52:67]
    v_add_f32 v10, 1.0, v10
    v_add_f32 v11, 1.0, v11
    v_add_f32 v12, 1.0, v12
    ds_read_b128 v[32:35], v8 offset:14336
    s_waitcnt lgkmcnt(4)
    v_mfma_f32_32x32x16_bf16 v[52:67], v[36:39], v[140:143], v[52:67]
    v_rcp_f32 v9, v9
    v_rcp_f32 v10, v10
    ds_read_b128 v[36:39], v8 offset:3072
    v_mfma_f32_32x32x16_bf16 v[52:67], v[40:43], v[144:147], v[52:67]
    v_rcp_f32 v11, v11
    v_rcp_f32 v12, v12
    ds_read_b128 v[40:43], v8 offset:7168
    s_waitcnt lgkmcnt(4)
    v_mfma_f32_32x32x16_bf16 v[52:67], v[44:47], v[148:151], v[52:67]
    v_mul_f32 v9, v9, v108
    v_mul_f32 v10, v10, v109
    v_mul_f32 v11, v11, v110
    ds_read_b128 v[44:47], v8 offset:11264
    v_mfma_f32_32x32x16_bf16 v[52:67], v[48:51], v[152:155], v[52:67]
    v_mul_f32 v12, v12, v111
    v_cvt_pk_bf16_f32 v24, v9, v10
    v_cvt_pk_bf16_f32 v25, v11, v12
    ds_read_b128 v[48:51], v8 offset:15360
    s_waitcnt lgkmcnt(4)
    v_mfma_f32_32x32x16_bf16 v[52:67], v[28:31], v[156:159], v[52:67]
    v_mul_f32 v13, 0xbfb8aa3b, v104
    v_mul_f32 v14, 0xbfb8aa3b, v105
    v_mul_f32 v15, 0xbfb8aa3b, v106
    ds_read_b128 v[28:31], v8 offset:16384
    v_mfma_f32_32x32x16_bf16 v[52:67], v[32:35], v[160:163], v[52:67]
    v_mul_f32 v16, 0xbfb8aa3b, v107
    v_exp_f32 v13, v13
    s_barrier
    ds_read_b128 v[32:35], v8 offset:20480
    s_waitcnt lgkmcnt(4)
    v_mfma_f32_32x32x16_bf16 v[52:67], v[36:39], v[164:167], v[52:67]
    v_exp_f32 v14, v14
    v_exp_f32 v15, v15
    ds_read_b128 v[36:39], v8 offset:24576
    v_mfma_f32_32x32x16_bf16 v[52:67], v[40:43], v[168:171], v[52:67]
    v_exp_f32 v16, v16
    v_add_f32 v13, 1.0, v13
    ds_read_b128 v[40:43], v8 offset:28672
    s_waitcnt lgkmcnt(4)
    v_mfma_f32_32x32x16_bf16 v[52:67], v[44:47], v[172:175], v[52:67]
    v_add_f32 v14, 1.0, v14
    v_add_f32 v15, 1.0, v15
    v_add_f32 v16, 1.0, v16
    ds_read_b128 v[44:47], v8 offset:17408
    v_mfma_f32_32x32x16_bf16 v[52:67], v[48:51], v[176:179], v[52:67]
    v_rcp_f32 v13, v13
    v_rcp_f32 v14, v14
    ds_read_b128 v[48:51], v8 offset:21504
    s_waitcnt lgkmcnt(4)
    v_mfma_f32_32x32x16_bf16 v[52:67], v[28:31], v[180:183], v[52:67]
    v_rcp_f32 v15, v15
    v_rcp_f32 v16, v16
    ds_read_b128 v[28:31], v8 offset:25600
    v_mfma_f32_32x32x16_bf16 v[52:67], v[32:35], v[184:187], v[52:67]
    v_mul_f32 v13, v13, v112
    v_mul_f32 v14, v14, v113
    v_mul_f32 v15, v15, v114
    ds_read_b128 v[32:35], v8 offset:29696
    s_waitcnt lgkmcnt(4)
    v_mfma_f32_32x32x16_bf16 v[52:67], v[36:39], v[188:191], v[52:67]
    v_mul_f32 v16, v16, v115
    v_cvt_pk_bf16_f32 v26, v13, v14
    v_cvt_pk_bf16_f32 v27, v15, v16
    ds_read_b128 v[36:39], v8 offset:18432
    v_mfma_f32_32x32x16_bf16 v[52:67], v[40:43], v[192:195], v[52:67]
    global_store_dwordx4 v4, v[24:27], s[6:7] offset:-1024 sc1
    ds_read_b128 v[40:43], v8 offset:22528
    s_waitcnt lgkmcnt(4)
    v_mfma_f32_32x32x16_bf16 v[52:67], v[44:47], v[196:199], v[52:67]
    ds_read_b128 v[44:47], v8 offset:26624
    v_mfma_f32_32x32x16_bf16 v[52:67], v[48:51], v[200:203], v[52:67]
    ds_read_b128 v[48:51], v8 offset:30720
    s_waitcnt lgkmcnt(4)
    v_mfma_f32_32x32x16_bf16 v[52:67], v[28:31], v[204:207], v[52:67]
    ds_read_b128 v[28:31], v4 offset:0
    v_mfma_f32_32x32x16_bf16 v[52:67], v[32:35], v[208:211], v[52:67]
    ds_read_b128 v[32:35], v4 offset:4096
    s_waitcnt lgkmcnt(4)
    v_mfma_f32_32x32x16_bf16 v[52:67], v[36:39], v[212:215], v[52:67]
    ds_read_b128 v[36:39], v4 offset:8192
    v_mfma_f32_32x32x16_bf16 v[52:67], v[40:43], v[216:219], v[52:67]
    ds_read_b128 v[40:43], v4 offset:12288
    s_waitcnt lgkmcnt(4)
    v_mfma_f32_32x32x16_bf16 v[52:67], v[44:47], v[220:223], v[52:67]
    ds_read_b128 v[44:47], v4 offset:1024
    v_mfma_f32_32x32x16_bf16 v[52:67], v[48:51], v[224:227], v[52:67]
    ds_read_b128 v[48:51], v4 offset:5120
    s_waitcnt lgkmcnt(4)
    v_mfma_f32_32x32x16_bf16 v[52:67], v[28:31], v[228:231], v[52:67]
    ds_read_b128 v[28:31], v4 offset:9216
    v_mfma_f32_32x32x16_bf16 v[52:67], v[32:35], v[232:235], v[52:67]
    ds_read_b128 v[32:35], v4 offset:13312
    s_waitcnt lgkmcnt(4)
    v_mfma_f32_32x32x16_bf16 v[52:67], v[36:39], v[236:239], v[52:67]
    ds_read_b128 v[36:39], v4 offset:2048
    v_mfma_f32_32x32x16_bf16 v[52:67], v[40:43], v[240:243], v[52:67]
    ds_read_b128 v[40:43], v4 offset:6144
    s_waitcnt lgkmcnt(4)
    v_mfma_f32_32x32x16_bf16 v[68:83], v[44:47], v[116:119], 0
    ds_read_b128 v[44:47], v4 offset:10240
    v_mfma_f32_32x32x16_bf16 v[68:83], v[48:51], v[120:123], v[68:83]
    s_nop 6
    v_mul_f32 v9, 0xbfb8aa3b, v52
    v_mul_f32 v10, 0xbfb8aa3b, v53
    v_mul_f32 v11, 0xbfb8aa3b, v54
    ds_read_b128 v[48:51], v4 offset:14336
    s_waitcnt lgkmcnt(4)
    v_mfma_f32_32x32x16_bf16 v[68:83], v[28:31], v[124:127], v[68:83]
    v_mul_f32 v12, 0xbfb8aa3b, v55
    v_exp_f32 v9, v9
    ds_read_b128 v[28:31], v4 offset:3072
    v_mfma_f32_32x32x16_bf16 v[68:83], v[32:35], v[128:131], v[68:83]
    v_exp_f32 v10, v10
    v_exp_f32 v11, v11
    ds_read_b128 v[32:35], v4 offset:7168
    s_waitcnt lgkmcnt(4)
    v_mfma_f32_32x32x16_bf16 v[68:83], v[36:39], v[132:135], v[68:83]
    v_exp_f32 v12, v12
    v_add_f32 v9, 1.0, v9
    ds_read_b128 v[36:39], v4 offset:11264
    v_mfma_f32_32x32x16_bf16 v[68:83], v[40:43], v[136:139], v[68:83]
    v_add_f32 v10, 1.0, v10
    v_add_f32 v11, 1.0, v11
    v_add_f32 v12, 1.0, v12
    s_waitcnt vmcnt(0)
    s_mov_b64 exec, 0xff
    global_store_dwordx4 v4, v[244:247], s[42:43] offset:128 sc1
    s_mov_b64 exec, -1
    v_mov_b32 v5, 163808
    v_mov_b32 v6, 1
    s_mov_b64 exec, 1
    ds_add_u32 v5, v6 offset:16
    s_mov_b64 exec, -1
    ds_read_b128 v[40:43], v4 offset:15360
    s_waitcnt lgkmcnt(4)
    v_mfma_f32_32x32x16_bf16 v[68:83], v[44:47], v[140:143], v[68:83]
    v_rcp_f32 v9, v9
    v_rcp_f32 v10, v10
    ds_read_b128 v[44:47], v4 offset:16384
    v_mfma_f32_32x32x16_bf16 v[68:83], v[48:51], v[144:147], v[68:83]
    v_rcp_f32 v11, v11
    v_rcp_f32 v12, v12
    ds_read_b128 v[48:51], v4 offset:20480
    s_waitcnt lgkmcnt(4)
    v_mfma_f32_32x32x16_bf16 v[68:83], v[28:31], v[148:151], v[68:83]
    v_mul_f32 v9, v9, v60
    v_mul_f32 v10, v10, v61
    v_mul_f32 v11, v11, v62
    ds_read_b128 v[28:31], v4 offset:24576
    v_mfma_f32_32x32x16_bf16 v[68:83], v[32:35], v[152:155], v[68:83]
    v_mul_f32 v12, v12, v63
    v_cvt_pk_bf16_f32 v20, v9, v10
    v_cvt_pk_bf16_f32 v21, v11, v12
    ds_read_b128 v[32:35], v4 offset:28672
    s_waitcnt lgkmcnt(4)
    v_mfma_f32_32x32x16_bf16 v[68:83], v[36:39], v[156:159], v[68:83]
    v_mul_f32 v13, 0xbfb8aa3b, v56
    v_mul_f32 v14, 0xbfb8aa3b, v57
    v_mul_f32 v15, 0xbfb8aa3b, v58
    ds_read_b128 v[36:39], v4 offset:17408
    v_mfma_f32_32x32x16_bf16 v[68:83], v[40:43], v[160:163], v[68:83]
    v_mul_f32 v16, 0xbfb8aa3b, v59
    v_exp_f32 v13, v13
    ds_read_b128 v[40:43], v4 offset:21504
    s_waitcnt lgkmcnt(4)
    v_mfma_f32_32x32x16_bf16 v[68:83], v[44:47], v[164:167], v[68:83]
    v_exp_f32 v14, v14
    v_exp_f32 v15, v15
    ds_read_b128 v[44:47], v4 offset:25600
    v_mfma_f32_32x32x16_bf16 v[68:83], v[48:51], v[168:171], v[68:83]
    v_exp_f32 v16, v16
    v_add_f32 v13, 1.0, v13
    ds_read_b128 v[48:51], v4 offset:29696
    s_waitcnt lgkmcnt(4)
    v_mfma_f32_32x32x16_bf16 v[68:83], v[28:31], v[172:175], v[68:83]
    v_add_f32 v14, 1.0, v14
    v_add_f32 v15, 1.0, v15
    v_add_f32 v16, 1.0, v16
    ds_read_b128 v[28:31], v4 offset:18432
    v_mfma_f32_32x32x16_bf16 v[68:83], v[32:35], v[176:179], v[68:83]
    v_rcp_f32 v13, v13
    v_rcp_f32 v14, v14
    ds_read_b128 v[32:35], v4 offset:22528
    s_waitcnt lgkmcnt(4)
    v_mfma_f32_32x32x16_bf16 v[68:83], v[36:39], v[180:183], v[68:83]
    v_rcp_f32 v15, v15
    v_rcp_f32 v16, v16
    ds_read_b128 v[36:39], v4 offset:26624
    v_mfma_f32_32x32x16_bf16 v[68:83], v[40:43], v[184:187], v[68:83]
    v_mul_f32 v13, v13, v64
    v_mul_f32 v14, v14, v65
    v_mul_f32 v15, v15, v66
    ds_read_b128 v[40:43], v4 offset:30720
    s_waitcnt lgkmcnt(4)
    v_mfma_f32_32x32x16_bf16 v[68:83], v[44:47], v[188:191], v[68:83]
    v_mul_f32 v16, v16, v67
    v_cvt_pk_bf16_f32 v22, v13, v14
    v_cvt_pk_bf16_f32 v23, v15, v16
    ds_read_b128 v[44:47], v4 offset:19456
    v_mfma_f32_32x32x16_bf16 v[68:83], v[48:51], v[192:195], v[68:83]
    global_store_dwordx4 v4, v[20:23], s[6:7] offset:0 sc1
    v_mov_b32 v5, 163808
    v_mov_b32 v6, 1
    s_mov_b64 exec, 1
    ds_add_u32 v5, v6 offset:4
    s_mov_b64 exec, -1
    ds_read_b128 v[48:51], v4 offset:23552
    s_waitcnt lgkmcnt(4)
    v_mfma_f32_32x32x16_bf16 v[68:83], v[28:31], v[196:199], v[68:83]
    ds_read_b128 v[28:31], v4 offset:27648
    v_mfma_f32_32x32x16_bf16 v[68:83], v[32:35], v[200:203], v[68:83]
    ds_read_b128 v[32:35], v4 offset:31744
    s_waitcnt lgkmcnt(4)
    v_mfma_f32_32x32x16_bf16 v[68:83], v[36:39], v[204:207], v[68:83]
    ds_read_b128 v[36:39], v4 offset:32768
    v_mfma_f32_32x32x16_bf16 v[68:83], v[40:43], v[208:211], v[68:83]
    ds_read_b128 v[40:43], v4 offset:36864
    s_waitcnt lgkmcnt(4)
    v_mfma_f32_32x32x16_bf16 v[68:83], v[44:47], v[212:215], v[68:83]
    ds_read_b128 v[44:47], v4 offset:40960
    v_mfma_f32_32x32x16_bf16 v[68:83], v[48:51], v[216:219], v[68:83]
    ds_read_b128 v[48:51], v4 offset:45056
    s_waitcnt lgkmcnt(4)
    v_mfma_f32_32x32x16_bf16 v[68:83], v[28:31], v[220:223], v[68:83]
    ds_read_b128 v[28:31], v4 offset:33792
    v_mfma_f32_32x32x16_bf16 v[68:83], v[32:35], v[224:227], v[68:83]
    ds_read_b128 v[32:35], v4 offset:37888
    s_waitcnt lgkmcnt(4)
    v_mfma_f32_32x32x16_bf16 v[68:83], v[36:39], v[228:231], v[68:83]
    ds_read_b128 v[36:39], v4 offset:41984
    v_mfma_f32_32x32x16_bf16 v[68:83], v[40:43], v[232:235], v[68:83]
    ds_read_b128 v[40:43], v4 offset:46080
    s_waitcnt lgkmcnt(4)
    v_mfma_f32_32x32x16_bf16 v[68:83], v[44:47], v[236:239], v[68:83]
    ds_read_b128 v[44:47], v4 offset:34816
    v_mfma_f32_32x32x16_bf16 v[68:83], v[48:51], v[240:243], v[68:83]
    ds_read_b128 v[48:51], v4 offset:38912
    s_waitcnt lgkmcnt(4)
    v_mfma_f32_32x32x16_bf16 v[84:99], v[28:31], v[116:119], 0
    ds_read_b128 v[28:31], v4 offset:43008
    v_mfma_f32_32x32x16_bf16 v[84:99], v[32:35], v[120:123], v[84:99]
    s_nop 6
    v_mul_f32 v9, 0xbfb8aa3b, v68
    v_mul_f32 v10, 0xbfb8aa3b, v69
    v_mul_f32 v11, 0xbfb8aa3b, v70
    ds_read_b128 v[32:35], v4 offset:47104
    s_waitcnt lgkmcnt(4)
    v_mfma_f32_32x32x16_bf16 v[84:99], v[36:39], v[124:127], v[84:99]
    v_mul_f32 v12, 0xbfb8aa3b, v71
    v_exp_f32 v9, v9
    ds_read_b128 v[36:39], v4 offset:35840
    v_mfma_f32_32x32x16_bf16 v[84:99], v[40:43], v[128:131], v[84:99]
    v_exp_f32 v10, v10
    v_exp_f32 v11, v11
    ds_read_b128 v[40:43], v4 offset:39936
    s_waitcnt lgkmcnt(4)
    v_mfma_f32_32x32x16_bf16 v[84:99], v[44:47], v[132:135], v[84:99]
    v_exp_f32 v12, v12
    v_add_f32 v9, 1.0, v9
    ds_read_b128 v[44:47], v4 offset:44032
    v_mfma_f32_32x32x16_bf16 v[84:99], v[48:51], v[136:139], v[84:99]
    v_add_f32 v10, 1.0, v10
    v_add_f32 v11, 1.0, v11
    v_add_f32 v12, 1.0, v12
    ds_read_b128 v[48:51], v4 offset:48128
    s_waitcnt lgkmcnt(4)
    v_mfma_f32_32x32x16_bf16 v[84:99], v[28:31], v[140:143], v[84:99]
    v_rcp_f32 v9, v9
    v_rcp_f32 v10, v10
    ds_read_b128 v[28:31], v4 offset:49152
    v_mfma_f32_32x32x16_bf16 v[84:99], v[32:35], v[144:147], v[84:99]
    v_rcp_f32 v11, v11
    v_rcp_f32 v12, v12
    ds_read_b128 v[32:35], v4 offset:53248
    s_waitcnt lgkmcnt(4)
    v_mfma_f32_32x32x16_bf16 v[84:99], v[36:39], v[148:151], v[84:99]
    v_mul_f32 v9, v9, v76
    v_mul_f32 v10, v10, v77
    v_mul_f32 v11, v11, v78
    ds_read_b128 v[36:39], v4 offset:57344
    v_mfma_f32_32x32x16_bf16 v[84:99], v[40:43], v[152:155], v[84:99]
    v_mul_f32 v12, v12, v79
    v_cvt_pk_bf16_f32 v24, v9, v10
    v_cvt_pk_bf16_f32 v25, v11, v12
    ds_read_b128 v[40:43], v4 offset:61440
    s_waitcnt lgkmcnt(4)
    v_mfma_f32_32x32x16_bf16 v[84:99], v[44:47], v[156:159], v[84:99]
    v_mul_f32 v13, 0xbfb8aa3b, v72
    v_mul_f32 v14, 0xbfb8aa3b, v73
    v_mul_f32 v15, 0xbfb8aa3b, v74
    ds_read_b128 v[44:47], v4 offset:50176
    v_mfma_f32_32x32x16_bf16 v[84:99], v[48:51], v[160:163], v[84:99]
    v_mul_f32 v16, 0xbfb8aa3b, v75
    v_exp_f32 v13, v13
    ds_read_b128 v[48:51], v4 offset:54272
    s_waitcnt lgkmcnt(4)
    v_mfma_f32_32x32x16_bf16 v[84:99], v[28:31], v[164:167], v[84:99]
    v_exp_f32 v14, v14
    v_exp_f32 v15, v15
    ds_read_b128 v[28:31], v4 offset:58368
    v_mfma_f32_32x32x16_bf16 v[84:99], v[32:35], v[168:171], v[84:99]
    v_exp_f32 v16, v16
    v_add_f32 v13, 1.0, v13
    ds_read_b128 v[32:35], v4 offset:62464
    s_waitcnt lgkmcnt(4)
    v_mfma_f32_32x32x16_bf16 v[84:99], v[36:39], v[172:175], v[84:99]
    v_add_f32 v14, 1.0, v14
    v_add_f32 v15, 1.0, v15
    v_add_f32 v16, 1.0, v16
    ds_read_b128 v[36:39], v4 offset:51200
    v_mfma_f32_32x32x16_bf16 v[84:99], v[40:43], v[176:179], v[84:99]
    v_rcp_f32 v13, v13
    v_rcp_f32 v14, v14
    ds_read_b128 v[40:43], v4 offset:55296
    s_waitcnt lgkmcnt(4)
    v_mfma_f32_32x32x16_bf16 v[84:99], v[44:47], v[180:183], v[84:99]
    v_rcp_f32 v15, v15
    v_rcp_f32 v16, v16
    ds_read_b128 v[44:47], v4 offset:59392
    v_mfma_f32_32x32x16_bf16 v[84:99], v[48:51], v[184:187], v[84:99]
    v_mul_f32 v13, v13, v80
    v_mul_f32 v14, v14, v81
    v_mul_f32 v15, v15, v82
    ds_read_b128 v[48:51], v4 offset:63488
    s_waitcnt lgkmcnt(4)
    v_mfma_f32_32x32x16_bf16 v[84:99], v[28:31], v[188:191], v[84:99]
    v_mul_f32 v16, v16, v83
    v_cvt_pk_bf16_f32 v26, v13, v14
    v_cvt_pk_bf16_f32 v27, v15, v16
    ds_read_b128 v[28:31], v4 offset:52224
    v_mfma_f32_32x32x16_bf16 v[84:99], v[32:35], v[192:195], v[84:99]
    global_store_dwordx4 v4, v[24:27], s[6:7] offset:1024 sc1
    v_mov_b32 v5, 163808
    v_mov_b32 v6, 1
    s_mov_b64 exec, 1
    ds_add_u32 v5, v6 offset:4
    s_mov_b64 exec, -1
    ds_read_b128 v[32:35], v4 offset:56320
    s_waitcnt lgkmcnt(4)
    v_mfma_f32_32x32x16_bf16 v[84:99], v[36:39], v[196:199], v[84:99]
    ds_read_b128 v[36:39], v4 offset:60416
    v_mfma_f32_32x32x16_bf16 v[84:99], v[40:43], v[200:203], v[84:99]
    ds_read_b128 v[40:43], v4 offset:64512
    s_waitcnt lgkmcnt(4)
    v_mfma_f32_32x32x16_bf16 v[84:99], v[44:47], v[204:207], v[84:99]
    ds_read_b128 v[44:47], v7 offset:0
    v_mfma_f32_32x32x16_bf16 v[84:99], v[48:51], v[208:211], v[84:99]
    ds_read_b128 v[48:51], v7 offset:4096
    s_waitcnt lgkmcnt(4)
    v_mfma_f32_32x32x16_bf16 v[84:99], v[28:31], v[212:215], v[84:99]
    ds_read_b128 v[28:31], v7 offset:8192
    v_mfma_f32_32x32x16_bf16 v[84:99], v[32:35], v[216:219], v[84:99]
    ds_read_b128 v[32:35], v7 offset:12288
    s_waitcnt lgkmcnt(4)
    v_mfma_f32_32x32x16_bf16 v[84:99], v[36:39], v[220:223], v[84:99]
    v_mfma_f32_32x32x16_bf16 v[84:99], v[40:43], v[224:227], v[84:99]
    s_waitcnt lgkmcnt(2)
    v_mfma_f32_32x32x16_bf16 v[84:99], v[44:47], v[228:231], v[84:99]
    v_mfma_f32_32x32x16_bf16 v[84:99], v[48:51], v[232:235], v[84:99]
    s_waitcnt lgkmcnt(0)
    v_mfma_f32_32x32x16_bf16 v[84:99], v[28:31], v[236:239], v[84:99]
    v_mfma_f32_32x32x16_bf16 v[84:99], v[32:35], v[240:243], v[84:99]
    s_nop 11
    v_mul_f32 v9, 0xbfb8aa3b, v84
    v_mul_f32 v10, 0xbfb8aa3b, v85
    v_mul_f32 v11, 0xbfb8aa3b, v86
    v_mul_f32 v12, 0xbfb8aa3b, v87
    v_exp_f32 v9, v9
    v_exp_f32 v10, v10
    v_exp_f32 v11, v11
    v_exp_f32 v12, v12
    v_add_f32 v9, 1.0, v9
    v_add_f32 v10, 1.0, v10
    v_add_f32 v11, 1.0, v11
    v_add_f32 v12, 1.0, v12
    v_rcp_f32 v9, v9
    v_rcp_f32 v10, v10
    v_rcp_f32 v11, v11
    v_rcp_f32 v12, v12
    v_mul_f32 v9, v9, v92
    v_mul_f32 v10, v10, v93
    v_mul_f32 v11, v11, v94
    v_mul_f32 v12, v12, v95
    v_cvt_pk_bf16_f32 v20, v9, v10
    v_cvt_pk_bf16_f32 v21, v11, v12
    v_mul_f32 v13, 0xbfb8aa3b, v88
    v_mul_f32 v14, 0xbfb8aa3b, v89
    v_mul_f32 v15, 0xbfb8aa3b, v90
    v_mul_f32 v16, 0xbfb8aa3b, v91
    v_exp_f32 v13, v13
    v_exp_f32 v14, v14
    v_exp_f32 v15, v15
    v_exp_f32 v16, v16
    v_add_f32 v13, 1.0, v13
    v_add_f32 v14, 1.0, v14
    v_add_f32 v15, 1.0, v15
    v_add_f32 v16, 1.0, v16
    v_rcp_f32 v13, v13
    v_rcp_f32 v14, v14
    v_rcp_f32 v15, v15
    v_rcp_f32 v16, v16
    v_mul_f32 v13, v13, v96
    v_mul_f32 v14, v14, v97
    v_mul_f32 v15, v15, v98
    v_mul_f32 v16, v16, v99
    v_cvt_pk_bf16_f32 v22, v13, v14
    v_cvt_pk_bf16_f32 v23, v15, v16
    global_store_dwordx4 v4, v[20:23], s[6:7] offset:2048 sc1
    v_mov_b32 v5, 163808
    v_mov_b32 v6, 1
    s_mov_b64 exec, 1
    ds_add_u32 v5, v6 offset:4
    s_mov_b64 exec, -1
    s_setprio 0
    s_waitcnt vmcnt(0)
    v_lshrrev_b32 v156, 3, v2
    v_mul_u32_u24 v3, 272, v156
    v_and_b32 v157, 7, v2
    v_lshl_add_u32 v3, v157, 5, v3
    s_mul_i32 s8, s3, 2176
    v_add_u32 v3, s8, v3
    v_lshlrev_b32 v4, 4, v157
    v_lshl_add_u32 v4, v156, 18, v4
    s_lshl_b32 s8, s32, 3
    s_add_u32 s8, s8, s3
    s_lshl_b32 s8, s8, 10
    s_lshl_b32 s9, s33, 7
    s_add_u32 s8, s8, s9
    s_add_u32 s44, s30, s8
    s_addc_u32 s45, s31, 0
    s_add_u32 s8, s8, 6291456
    s_add_u32 s46, s34, s8
    s_addc_u32 s47, s35, 0
    s_barrier
    s_or_b32 s11, s2, s3
    s_cmp_eq_u32 s11, 0
    s_cbranch_scc0 Lne24
    v_mov_b32 v5, 0
    v_mov_b32 v6, s40
    s_mov_b64 exec, 1
    global_store_dword v5, v6, s[48:49] sc1
    s_mov_b64 exec, -1
Lne24:
    global_load_dwordx4 v[148:151], v4, s[46:47] sc1
    s_waitcnt vmcnt(0)
    v_lshlrev_b32 v164, 16, v148
    v_and_b32 v165, 0xffff0000, v148
    v_lshlrev_b32 v166, 16, v149
    v_and_b32 v167, 0xffff0000, v149
    v_lshlrev_b32 v168, 16, v150
    v_and_b32 v169, 0xffff0000, v150
    v_lshlrev_b32 v170, 16, v151
    v_and_b32 v171, 0xffff0000, v151
    s_barrier
    ds_read_b128 v[116:119], v3 offset:0
    ds_read_b128 v[120:123], v3 offset:17408
    ds_read_b128 v[124:127], v3 offset:34816
    ds_read_b128 v[128:131], v3 offset:52224
    ds_read_b128 v[132:135], v3 offset:16
    ds_read_b128 v[136:139], v3 offset:17424
    ds_read_b128 v[140:143], v3 offset:34832
    ds_read_b128 v[144:147], v3 offset:52240
    s_waitcnt lgkmcnt(4)
    v_pk_add_f32 v[116:117], v[116:117], v[120:121]
    v_pk_add_f32 v[124:125], v[124:125], v[128:129]
    v_pk_add_f32 v[118:119], v[118:119], v[122:123]
    v_pk_add_f32 v[126:127], v[126:127], v[130:131]
    v_pk_add_f32 v[116:117], v[116:117], v[124:125]
    v_pk_add_f32 v[118:119], v[118:119], v[126:127]
    v_cvt_pk_bf16_f32 v117, v116, v117
    v_cvt_pk_bf16_f32 v119, v118, v119
    v_lshlrev_b32 v116, 16, v117
    v_and_b32 v117, 0xffff0000, v117
    v_lshlrev_b32 v118, 16, v119
    v_and_b32 v119, 0xffff0000, v119
    v_pk_add_f32 v[116:117], v[116:117], v[164:165]
    v_pk_add_f32 v[118:119], v[118:119], v[166:167]
    v_cvt_pk_bf16_f32 v152, v116, v117
    v_cvt_pk_bf16_f32 v153, v118, v119
    s_waitcnt lgkmcnt(0)
    v_pk_add_f32 v[132:133], v[132:133], v[136:137]
    v_pk_add_f32 v[140:141], v[140:141], v[144:145]
    v_pk_add_f32 v[134:135], v[134:135], v[138:139]
    v_pk_add_f32 v[142:143], v[142:143], v[146:147]
    v_pk_add_f32 v[132:133], v[132:133], v[140:141]
    v_pk_add_f32 v[134:135], v[134:135], v[142:143]
    v_cvt_pk_bf16_f32 v133, v132, v133
    v_cvt_pk_bf16_f32 v135, v134, v135
    v_lshlrev_b32 v132, 16, v133
    v_and_b32 v133, 0xffff0000, v133
    v_lshlrev_b32 v134, 16, v135
    v_and_b32 v135, 0xffff0000, v135
    v_pk_add_f32 v[132:133], v[132:133], v[168:169]
    v_pk_add_f32 v[134:135], v[134:135], v[170:171]
    v_cvt_pk_bf16_f32 v154, v132, v133
    v_cvt_pk_bf16_f32 v155, v134, v135
    global_store_dwordx4 v4, v[152:155], s[44:45] sc1
    s_endpgm
L_helper:
    s_sub_u32 s3, s3, 4
    s_waitcnt lgkmcnt(0)
    s_barrier
    s_setprio 2
    s_lshr_b32 s8, s39, 5
    s_lshl_b32 s9, s3, 9
    s_add_u32 s8, s8, s9
    v_lshl_add_u32 v4, v2, 3, s8
    s_and_b32 s9, s39, 7
    s_lshl_b32 s9, s9, 6
    s_and_b32 s10, s39, 8
    s_lshl_b32 s10, s10, 1
    s_add_u32 s9, s9, s10
    s_sub_u32 s10, 498, s9
    s_bitcmp1_b32 s39, 4
    s_cselect_b32 s9, s10, s9
    s_cselect_b32 s10, -1, 1
    v_mul_i32_i24 v4, s10, v4
    v_and_b32 v4, 0x7ff, v4
    v_mul_u32_u24 v24, 514, v4
    v_add_u32 v24, s9, v24
    s_add_u32 s48, s34, 20447232
    s_addc_u32 s49, s35, 0
    v_mov_b32 v4, 0
    global_load_dword v32, v4, s[48:49] sc1
    v_lshlrev_b32 v3, 4, v2
    s_lshl_b32 s8, s3, 10
    s_add_u32 s8, s8, 149504
    v_lshl_add_u32 v34, v2, 4, s8
    v_mov_b32 v7, 163808
    v_mov_b32 v5, 1
    s_setprio 0
    v_lshlrev_b32 v3, 4, v2
    s_lshl_b32 s58, s3, 12
    v_lshrrev_b32 v4, 5, v2
    v_bfe_u32 v5, v2, 3, 2
    v_lshl_add_u32 v4, v4, 4, v5
    v_mul_u32_u24 v28, 3584, v4
    v_and_b32 v4, 7, v2
    v_lshl_add_u32 v28, v4, 4, v28
    s_mul_i32 s8, s3, 114688
    v_add_u32 v28, s8, v28
    v_add_u32 v29, 917504, v28
    v_and_b32 v5, 16, v2
    v_lshlrev_b32 v5, 1, v5
    v_xor_b32 v50, v5, v28
    v_xor_b32 v51, v5, v29
    v_xor_b32 v52, 64, v50
    v_xor_b32 v53, 64, v51
    s_lshl_b32 s8, s37, 7
    s_and_b32 s42, s36, 7
    s_add_u32 s10, s24, s8
    s_addc_u32 s11, s25, 0
    s_add_u32 s12, s26, s8
    s_addc_u32 s13, s27, 0
    v_bfe_u32 v4, v2, 5, 1
    v_bfe_u32 v5, v2, 2, 2
    v_lshl_add_u32 v4, v4, 2, v5
    v_and_b32 v35, 3, v2
    v_lshl_add_u32 v35, v35, 3, s58
    v_lshl_add_u32 v42, v4, 7, v35
    v_bfe_u32 v5, v2, 4, 1
    v_lshl_add_u32 v42, v5, 11, v42
    v_lshl_add_u32 v42, v5, 6, v42
    v_and_b32 v43, 8, v2
    v_lshl_add_u32 v42, v43, 2, v42
    v_xor_b32 v43, 32, v42
    v_xor_b32 v44, 64, v42
    v_xor_b32 v45, 96, v42
    v_add_u32 v46, 0x10000, v42
    v_add_u32 v47, 0x10000, v43
    v_add_u32 v48, 0x10000, v44
    v_add_u32 v49, 0x10000, v45
    v_add_u32 v6, s58, v3
    v_add_u32 v37, 0x10000, v6
    s_mul_i32 s9, s37, 3
    s_lshr_b32 s9, s9, 2
    s_lshl_b32 s9, s9, 3
    v_and_b32 v36, 15, v2
    v_add_u32 v36, s9, v36
    v_min_u32 v36, 95, v36
    s_lshl_b32 s9, s33, 2
    s_add_u32 s9, s9, s3
    s_mul_i32 s9, s9, 7
    s_lshr_b32 s8, s9, 1
    s_add_u32 s8, s8, 96
    v_and_b32 v4, 3, v2
    v_add_u32 v4, s8, v4
    v_cmp_lt_u32 vcc, 31, v2
    s_nop 1
    v_cndmask_b32 v36, v36, v4, vcc
    v_lshlrev_b32 v36, 7, v36
    s_lshl_b32 s9, s9, 13
    s_add_u32 s9, s9, 4194304
    s_add_u32 s62, s34, s9
    s_addc_u32 s63, s35, 0
    s_add_u32 s56, s34, 6225920
    s_addc_u32 s57, s35, 0
    s_add_u32 s59, s58, 0
    v_bfe_u32 v4, v2, 5, 1
    v_bfe_u32 v5, v2, 2, 2
    v_lshl_add_u32 v4, v4, 2, v5
    v_and_b32 v35, 3, v2
    v_lshl_add_u32 v35, v35, 3, s59
    v_lshl_add_u32 v38, v4, 7, v35
    v_bfe_u32 v5, v2, 4, 1
    s_cmp_ge_u32 s38, 96
    s_cbranch_scc1 Lpd25
    v_lshl_add_u32 v38, v5, 11, v38
    v_mov_b32 v40, v28
    v_mov_b32 v41, v29
    s_lshr_b32 s43, s38, 3
    s_and_b32 s8, s38, 1
    s_lshl_b32 s8, s8, 7
    s_bfe_u32 s9, s38, 0x20001
    s_lshl_b32 s9, s9, 2
    s_add_u32 s8, s8, s9
    s_mul_i32 s8, s8, 3584
    s_lshl_b32 s9, s43, 7
    s_add_u32 s8, s8, s9
    s_add_u32 s8, s8, 2048
    s_add_u32 s44, s24, s8
    s_addc_u32 s45, s25, 0
    s_add_u32 s46, s26, s8
    s_addc_u32 s47, s27, 0
    s_and_b32 s8, s38, 7
    s_lshl_b32 s8, s8, 2
    s_add_u32 s8, s8, s3
    s_add_u32 s8, s8, s9
    s_lshl_b32 s8, s8, 10
    s_add_u32 s8, s8, 29097984
    s_mov_b32 s54, 32768
    s_add_u32 s60, s34, s8
    s_addc_u32 s61, s35, 0
    s_branch Lpe26
Lpd25:
    v_lshl_add_u32 v38, v5, 5, v38
    v_lshrrev_b32 v5, 3, v2
    v_lshlrev_b32 v40, 10, v5
    v_and_b32 v4, 7, v2
    v_lshl_add_u32 v40, v4, 4, v40
    v_add_u32 v41, 8192, v40
    s_sub_u32 s8, s38, 96
    s_min_u32 s8, s8, 111
    s_lshl_b32 s8, s8, 1
    s_lshr_b32 s9, s3, 1
    s_add_u32 s8, s8, s9
    s_mul_i32 s43, s8, 9363
    s_lshr_b32 s43, s43, 16
    s_mul_i32 s14, s43, 7
    s_sub_u32 s55, s8, s14
    s_and_b32 s14, s43, 3
    s_lshl_b32 s14, s14, 2
    s_and_b32 s9, s3, 1
    s_lshl_b32 s9, s9, 1
    s_add_u32 s14, s14, s9
    s_lshl_b32 s8, s8, 2
    s_add_u32 s8, s8, s9
    s_lshl_b32 s8, s8, 11
    s_add_u32 s8, s8, 4194304
    s_add_u32 s60, s34, s8
    s_addc_u32 s61, s35, 0
    s_lshr_b32 s43, s43, 2
    s_lshl_b32 s43, s43, 7
    s_cmp_lt_u32 s55, 4
    s_cselect_b32 s9, 4, 3
    s_cselect_b32 s8, 0, 60
    s_mul_i32 s14, s14, s9
    s_add_u32 s14, s14, s55
    s_add_u32 s14, s14, s8
    s_lshl_b32 s14, s14, 14
    s_add_u32 s14, s14, s43
    s_lshl_b32 s9, s9, 14
    s_mov_b32 s54, 1024
    s_add_u32 s44, s28, s14
    s_addc_u32 s45, s29, 0
    s_add_u32 s46, s44, s9
    s_addc_u32 s47, s45, 0
Lpe26:
    s_waitcnt vmcnt(0)
    s_cmp_ge_u32 s38, 208
    s_cbranch_scc1 Lnp27
    s_add_u32 m0, s59, 0
    s_nop 0
    global_load_lds_dwordx4 v40, s[44:45]
    s_add_u32 m0, s59, 1024
    s_nop 0
    global_load_lds_dwordx4 v41, s[44:45]
    s_add_u32 m0, s59, 2048
    s_nop 0
    global_load_lds_dwordx4 v40, s[46:47]
    s_add_u32 m0, s59, 3072
    s_nop 0
    global_load_lds_dwordx4 v41, s[46:47]
    s_waitcnt vmcnt(0)
    s_cmp_ge_u32 s38, 96
    s_cbranch_scc1 Lpd28
    ds_read_b64_tr_b16 v[208:209], v38 offset:0
    ds_read_b64_tr_b16 v[210:211], v38 offset:1024
    ds_read_b64_tr_b16 v[212:213], v38 offset:32
    ds_read_b64_tr_b16 v[214:215], v38 offset:1056
    ds_read_b64_tr_b16 v[216:217], v38 offset:64
    ds_read_b64_tr_b16 v[218:219], v38 offset:1088
    ds_read_b64_tr_b16 v[220:221], v38 offset:96
    ds_read_b64_tr_b16 v[222:223], v38 offset:1120
    s_branch Lpe29
Lpd28:
    ds_read_b64_tr_b16 v[208:209], v38 offset:0
    ds_read_b64_tr_b16 v[210:211], v38 offset:1024
    ds_read_b64_tr_b16 v[212:213], v38 offset:64
    ds_read_b64_tr_b16 v[214:215], v38 offset:1088
    ds_read_b64_tr_b16 v[216:217], v38 offset:2048
    ds_read_b64_tr_b16 v[218:219], v38 offset:3072
    ds_read_b64_tr_b16 v[220:221], v38 offset:2112
    ds_read_b64_tr_b16 v[222:223], v38 offset:3136
Lpe29:
    s_waitcnt lgkmcnt(0)
Lnp27:
    s_mov_b32 s15, 16777216
Lsp30:
    ds_read_b32 v14, v7 offset:0
    s_sub_u32 s15, s15, 1
    s_cbranch_scc1 L_end
    s_waitcnt lgkmcnt(0)
    v_cmp_gt_u32 vcc, 4, v14
    s_sleep 1
    s_cbranch_vccnz Lsp30
    s_sleep 6
    global_load_dwordx4 v[56:59], v24, s[18:19]
    global_load_dwordx4 v[60:63], v24, s[20:21]
    v_mov_b32 v5, 1
    s_and_b32 s8, s39, 0x18
    s_cmp_eq_u32 s8, 0
    s_cbranch_scc0 Lnsp31
    global_load_ushort v64, v24, s[18:19] offset:32
    global_load_ushort v65, v24, s[20:21] offset:32
    s_waitcnt vmcnt(0)
    s_mov_b32 s8, 0xffff0000
    v_and_or_b32 v56, v56, s8, v64
    v_and_or_b32 v60, v60, s8, v65
Lnsp31:
    s_waitcnt vmcnt(0)
    ds_write_b128 v34, v[56:59] offset:0
    ds_write_b128 v34, v[60:63] offset:4096
    s_mov_b64 exec, 1
    ds_add_u32 v7, v5 offset:8
    s_mov_b64 exec, -1
    v_readfirstlane_b32 s40, v32
    s_nop 0
    s_add_u32 s40, s40, 1
    s_or_b32 s40, s40, 0xffff0000
    v_mov_b32 v73, s40
    v_mov_b32 v75, s40
    s_cmp_ge_u32 s38, 208
    s_cbranch_scc1 Lnp32
    global_store_dwordx4 v3, v[208:211], s[60:61] sc1
    s_add_u32 s60, s60, s54
    s_addc_u32 s61, s61, 0
    global_store_dwordx4 v3, v[212:215], s[60:61] sc1
    s_add_u32 s60, s60, s54
    s_addc_u32 s61, s61, 0
    global_store_dwordx4 v3, v[216:219], s[60:61] sc1
    s_add_u32 s60, s60, s54
    s_addc_u32 s61, s61, 0
    global_store_dwordx4 v3, v[220:223], s[60:61] sc1
Lnp32:
    s_waitcnt vmcnt(0)
    v_mov_b32 v35, 1
    s_mov_b64 exec, 1
    ds_add_rtn_u32 v35, v7, v35 offset:20
    s_mov_b64 exec, -1
    s_waitcnt lgkmcnt(0)
    v_readfirstlane_b32 s8, v35
    s_nop 0
    s_cmp_eq_u32 s8, 3
    s_cbranch_scc0 Lnofl33
    s_lshl_b32 s8, s38, 7
    s_add_u32 s8, s8, 0
    s_add_u32 s4, s56, s8
    s_addc_u32 s5, s57, 0
    s_mov_b64 exec, 0xff
    global_store_dwordx4 v3, v[72:75], s[4:5] sc1
    s_mov_b64 exec, -1
Lnofl33:
    s_mov_b32 s15, 16777216
Lsp34:
    ds_read_b32 v14, v7 offset:0
    s_sub_u32 s15, s15, 1
    s_cbranch_scc1 L_end
    s_waitcnt lgkmcnt(0)
    v_cmp_gt_u32 vcc, 8, v14
    s_sleep 1
    s_cbranch_vccnz Lsp34
    s_add_u32 s8, s42, 0
    s_and_b32 s8, s8, 7
    s_lshl_b32 s14, s8, 14
    s_add_u32 s14, s14, s58
    s_and_b32 s9, s8, 1
    s_lshl_b32 s9, s9, 7
    s_lshr_b32 s8, s8, 1
    s_lshl_b32 s8, s8, 2
    s_add_u32 s8, s8, s9
    s_mul_i32 s8, s8, 3584
    s_add_u32 s4, s10, s8
    s_addc_u32 s5, s11, 0
    s_add_u32 s6, s12, s8
    s_addc_u32 s7, s13, 0
    s_add_u32 m0, s14, 0
    s_nop 0
    global_load_lds_dwordx4 v50, s[4:5]
    s_add_u32 m0, s14, 1024
    s_nop 0
    global_load_lds_dwordx4 v51, s[4:5]
    s_add_u32 m0, s14, 2048
    s_nop 0
    global_load_lds_dwordx4 v52, s[6:7]
    s_add_u32 m0, s14, 3072
    s_nop 0
    global_load_lds_dwordx4 v53, s[6:7]
    s_add_u32 s8, s42, 1
    s_and_b32 s8, s8, 7
    s_lshl_b32 s14, s8, 14
    s_add_u32 s14, s14, s58
    s_and_b32 s9, s8, 1
    s_lshl_b32 s9, s9, 7
    s_lshr_b32 s8, s8, 1
    s_lshl_b32 s8, s8, 2
    s_add_u32 s8, s8, s9
    s_mul_i32 s8, s8, 3584
    s_add_u32 s4, s10, s8
    s_addc_u32 s5, s11, 0
    s_add_u32 s6, s12, s8
    s_addc_u32 s7, s13, 0
    s_add_u32 m0, s14, 0
    s_nop 0
    global_load_lds_dwordx4 v50, s[4:5]
    s_waitcnt vmcnt(4)
    s_add_u32 m0, s14, 1024
    s_nop 0
    global_load_lds_dwordx4 v51, s[4:5]
    s_waitcnt vmcnt(4)
    s_add_u32 m0, s14, 2048
    s_nop 0
    global_load_lds_dwordx4 v52, s[6:7]
    s_waitcnt vmcnt(4)
    s_add_u32 m0, s14, 3072
    s_nop 0
    global_load_lds_dwordx4 v53, s[6:7]
    s_waitcnt vmcnt(4)
    s_add_u32 s8, s42, 2
    s_and_b32 s8, s8, 7
    s_lshl_b32 s14, s8, 14
    s_add_u32 s14, s14, s58
    s_and_b32 s9, s8, 1
    s_lshl_b32 s9, s9, 7
    s_lshr_b32 s8, s8, 1
    s_lshl_b32 s8, s8, 2
    s_add_u32 s8, s8, s9
    s_mul_i32 s8, s8, 3584
    s_add_u32 s4, s10, s8
    s_addc_u32 s5, s11, 0
    s_add_u32 s6, s12, s8
    s_addc_u32 s7, s13, 0
    s_add_u32 m0, s14, 0
    s_nop 0
    global_load_lds_dwordx4 v50, s[4:5]
    s_waitcnt vmcnt(4)
    s_add_u32 m0, s14, 1024
    s_nop 0
    global_load_lds_dwordx4 v51, s[4:5]
    s_waitcnt vmcnt(4)
    s_add_u32 m0, s14, 2048
    s_nop 0
    global_load_lds_dwordx4 v52, s[6:7]
    s_waitcnt vmcnt(4)
    s_add_u32 m0, s14, 3072
    s_nop 0
    global_load_lds_dwordx4 v53, s[6:7]
    s_waitcnt vmcnt(4)
    s_add_u32 s8, s42, 3
    s_and_b32 s8, s8, 7
    s_lshl_b32 s14, s8, 14
    s_add_u32 s14, s14, s58
    s_and_b32 s9, s8, 1
    s_lshl_b32 s9, s9, 7
    s_lshr_b32 s8, s8, 1
    s_lshl_b32 s8, s8, 2
    s_add_u32 s8, s8, s9
    s_mul_i32 s8, s8, 3584
    s_add_u32 s4, s10, s8
    s_addc_u32 s5, s11, 0
    s_add_u32 s6, s12, s8
    s_addc_u32 s7, s13, 0
    s_add_u32 m0, s14, 0
    s_nop 0
    global_load_lds_dwordx4 v50, s[4:5]
    s_waitcnt vmcnt(4)
    s_add_u32 m0, s14, 1024
    s_nop 0
    global_load_lds_dwordx4 v51, s[4:5]
    s_waitcnt vmcnt(4)
    s_add_u32 m0, s14, 2048
    s_nop 0
    global_load_lds_dwordx4 v52, s[6:7]
    s_waitcnt vmcnt(4)
    s_add_u32 m0, s14, 3072
    s_nop 0
    global_load_lds_dwordx4 v53, s[6:7]
    s_waitcnt vmcnt(4)
    s_add_u32 s8, s42, 4
    s_and_b32 s8, s8, 7
    s_lshl_b32 s14, s8, 14
    s_add_u32 s14, s14, s58
    s_and_b32 s9, s8, 1
    s_lshl_b32 s9, s9, 7
    s_lshr_b32 s8, s8, 1
    s_lshl_b32 s8, s8, 2
    s_add_u32 s8, s8, s9
    s_mul_i32 s8, s8, 3584
    s_add_u32 s4, s10, s8
    s_addc_u32 s5, s11, 0
    s_add_u32 s6, s12, s8
    s_addc_u32 s7, s13, 0
    s_add_u32 m0, s14, 0
    s_nop 0
    global_load_lds_dwordx4 v50, s[4:5]
    s_waitcnt vmcnt(4)
    s_add_u32 m0, s14, 1024
    s_nop 0
    global_load_lds_dwordx4 v51, s[4:5]
    s_waitcnt vmcnt(4)
    s_add_u32 m0, s14, 2048
    s_nop 0
    global_load_lds_dwordx4 v52, s[6:7]
    s_waitcnt vmcnt(4)
    s_add_u32 m0, s14, 3072
    s_nop 0
    global_load_lds_dwordx4 v53, s[6:7]
    s_waitcnt vmcnt(4)
    s_add_u32 s8, s42, 5
    s_and_b32 s8, s8, 7
    s_lshl_b32 s14, s8, 14
    s_add_u32 s14, s14, s58
    s_and_b32 s9, s8, 1
    s_lshl_b32 s9, s9, 7
    s_lshr_b32 s8, s8, 1
    s_lshl_b32 s8, s8, 2
    s_add_u32 s8, s8, s9
    s_mul_i32 s8, s8, 3584
    s_add_u32 s4, s10, s8
    s_addc_u32 s5, s11, 0
    s_add_u32 s6, s12, s8
    s_addc_u32 s7, s13, 0
    s_add_u32 m0, s14, 0
    s_nop 0
    global_load_lds_dwordx4 v50, s[4:5]
    s_waitcnt vmcnt(4)
    s_add_u32 m0, s14, 1024
    s_nop 0
    global_load_lds_dwordx4 v51, s[4:5]
    s_waitcnt vmcnt(4)
    s_add_u32 m0, s14, 2048
    s_nop 0
    global_load_lds_dwordx4 v52, s[6:7]
    s_waitcnt vmcnt(4)
    s_add_u32 m0, s14, 3072
    s_nop 0
    global_load_lds_dwordx4 v53, s[6:7]
    s_waitcnt vmcnt(4)
    s_add_u32 s8, s42, 6
    s_and_b32 s8, s8, 7
    s_lshl_b32 s14, s8, 14
    s_add_u32 s14, s14, s58
    s_and_b32 s9, s8, 1
    s_lshl_b32 s9, s9, 7
    s_lshr_b32 s8, s8, 1
    s_lshl_b32 s8, s8, 2
    s_add_u32 s8, s8, s9
    s_mul_i32 s8, s8, 3584
    s_add_u32 s4, s10, s8
    s_addc_u32 s5, s11, 0
    s_add_u32 s6, s12, s8
    s_addc_u32 s7, s13, 0
    s_add_u32 m0, s14, 0
    s_nop 0
    global_load_lds_dwordx4 v50, s[4:5]
    s_waitcnt vmcnt(4)
    s_add_u32 m0, s14, 1024
    s_nop 0
    global_load_lds_dwordx4 v51, s[4:5]
    s_waitcnt vmcnt(4)
    s_add_u32 m0, s14, 2048
    s_nop 0
    global_load_lds_dwordx4 v52, s[6:7]
    s_waitcnt vmcnt(4)
    s_add_u32 m0, s14, 3072
    s_nop 0
    global_load_lds_dwordx4 v53, s[6:7]
    s_waitcnt vmcnt(4)
    s_add_u32 s8, s42, 7
    s_and_b32 s8, s8, 7
    s_lshl_b32 s14, s8, 14
    s_add_u32 s14, s14, s58
    s_and_b32 s9, s8, 1
    s_lshl_b32 s9, s9, 7
    s_lshr_b32 s8, s8, 1
    s_lshl_b32 s8, s8, 2
    s_add_u32 s8, s8, s9
    s_mul_i32 s8, s8, 3584
    s_add_u32 s4, s10, s8
    s_addc_u32 s5, s11, 0
    s_add_u32 s6, s12, s8
    s_addc_u32 s7, s13, 0
    s_add_u32 m0, s14, 0
    s_nop 0
    global_load_lds_dwordx4 v50, s[4:5]
    s_waitcnt vmcnt(4)
    s_add_u32 m0, s14, 1024
    s_nop 0
    global_load_lds_dwordx4 v51, s[4:5]
    s_waitcnt vmcnt(4)
    s_add_u32 m0, s14, 2048
    s_nop 0
    global_load_lds_dwordx4 v52, s[6:7]
    s_waitcnt vmcnt(4)
    s_add_u32 m0, s14, 3072
    s_nop 0
    global_load_lds_dwordx4 v53, s[6:7]
    global_load_dwordx4 v[8:11], v36, s[56:57] sc1
    s_waitcnt vmcnt(0)
    v_and_b32 v4, v9, v11
    v_or_b32 v5, v9, v11
    v_xor_b32 v4, s40, v4
    v_xor_b32 v5, s40, v5
    v_or_b32 v4, v4, v5
    v_cmp_ne_u32 vcc, 0, v4
    s_cbranch_vccnz Lpoll35
Lok36:
    s_add_u32 s42, s62, 4096
    s_addc_u32 s43, s63, 0
    global_load_dwordx4 v[88:91], v3, s[42:43] offset:-4096 sc1
    global_load_dwordx4 v[92:95], v3, s[42:43] offset:-3072 sc1
    global_load_dwordx4 v[96:99], v3, s[42:43] offset:-2048 sc1
    global_load_dwordx4 v[100:103], v3, s[42:43] offset:-1024 sc1
    global_load_dwordx4 v[104:107], v3, s[42:43] offset:0 sc1
    global_load_dwordx4 v[108:111], v3, s[42:43] offset:1024 sc1
    global_load_dwordx4 v[112:115], v3, s[42:43] offset:2048 sc1
    global_load_dwordx4 v[116:119], v3, s[42:43] offset:3072 sc1
    s_waitcnt vmcnt(6)
    s_add_u32 s42, s62, 12288
    s_addc_u32 s43, s63, 0
    global_load_dwordx4 v[120:123], v3, s[42:43] offset:-4096 sc1
    global_load_dwordx4 v[124:127], v3, s[42:43] offset:-3072 sc1
    s_waitcnt vmcnt(6)
    global_load_dwordx4 v[128:131], v3, s[42:43] offset:-2048 sc1
    global_load_dwordx4 v[132:135], v3, s[42:43] offset:-1024 sc1
    s_waitcnt vmcnt(6)
    global_load_dwordx4 v[136:139], v3, s[42:43] offset:0 sc1
    global_load_dwordx4 v[140:143], v3, s[42:43] offset:1024 sc1
    s_waitcnt vmcnt(6)
    global_load_dwordx4 v[144:147], v3, s[42:43] offset:2048 sc1
    global_load_dwordx4 v[148:151], v3, s[42:43] offset:3072 sc1
    s_waitcnt vmcnt(6)
    s_add_u32 s42, s62, 20480
    s_addc_u32 s43, s63, 0
    global_load_dwordx4 v[152:155], v3, s[42:43] offset:-4096 sc1
    global_load_dwordx4 v[156:159], v3, s[42:43] offset:-3072 sc1
    s_waitcnt vmcnt(6)
    global_load_dwordx4 v[160:163], v3, s[42:43] offset:-2048 sc1
    global_load_dwordx4 v[164:167], v3, s[42:43] offset:-1024 sc1
    s_waitcnt vmcnt(6)
    global_load_dwordx4 v[168:171], v3, s[42:43] offset:0 sc1
    global_load_dwordx4 v[172:175], v3, s[42:43] offset:1024 sc1
    s_waitcnt vmcnt(6)
    global_load_dwordx4 v[176:179], v3, s[42:43] offset:2048 sc1
    global_load_dwordx4 v[180:183], v3, s[42:43] offset:3072 sc1
    s_waitcnt vmcnt(6)
    s_add_u32 s42, s62, 28672
    s_addc_u32 s43, s63, 0
    global_load_dwordx4 v[184:187], v3, s[42:43] offset:-4096 sc1
    global_load_dwordx4 v[188:191], v3, s[42:43] offset:-3072 sc1
    s_lshl_b32 s8, s36, 2
    s_add_u32 s8, s8, s3
    s_lshl_b32 s8, s8, 4
    s_add_u32 s8, s8, s37
    s_mul_i32 s8, s8, 9216
    s_add_u32 s8, s8, 10489856
    s_add_u32 s4, s34, s8
    s_addc_u32 s5, s35, 0
    v_mov_b32 v224, -1
    v_mov_b32 v225, -1
    v_mov_b32 v226, -1
    v_mov_b32 v227, -1
    global_store_dwordx4 v3, v[224:227], s[4:5] offset:0 sc1
    global_store_dwordx4 v3, v[224:227], s[4:5] offset:1024 sc1
    global_store_dwordx4 v3, v[224:227], s[4:5] offset:2048 sc1
    s_mul_i32 s8, s37, 98304
    s_lshl_b32 s9, s3, 10
    s_add_u32 s8, s8, s9
    s_add_u32 s8, s8, 29097984
    s_add_u32 s50, s34, s8
    s_addc_u32 s51, s35, 0
    s_waitcnt lgkmcnt(0)
    s_lshl_b32 s8, s32, 5
    s_lshl_b32 s9, s3, 2
    s_add_u32 s8, s8, s9
    v_and_b32 v16, 3, v2
    v_bfe_u32 v14, v2, 2, 1
    v_lshl_add_u32 v16, v14, 4, v16
    v_add_u32 v16, s8, v16
    v_lshlrev_b32 v16, 9, v16
    s_mul_i32 s8, s8, 9216
    s_add_u32 s8, s8, 10485760
    s_add_u32 s52, s34, s8
    s_addc_u32 s53, s35, 0
    s_add_u32 s48, s34, 19922944
    s_addc_u32 s49, s35, 0
    v_and_b32 v14, 31, v2
    v_mul_u32_u24 v15, 272, v14
    v_lshrrev_b32 v14, 5, v2
    v_lshl_add_u32 v15, v14, 4, v15
    s_mul_i32 s8, s3, 17408
    v_add_u32 v15, s8, v15
    s_add_u32 s41, s3, 4
    s_waitcnt lgkmcnt(0)
    s_barrier
    s_setprio 2
    s_lshl_b32 s8, s3, 11
    s_add_u32 s8, s8, 140288
    v_add_u32 v4, s8, v3
    ds_read_b128 v[208:211], v4 offset:0
    ds_read_b128 v[212:215], v4 offset:1024
    s_lshl_b32 s8, s3, 9
    s_add_u32 s8, s8, s38
    s_lshl_b32 s8, s8, 10
    s_add_u32 s8, s8, 6291456
    s_add_u32 s44, s34, s8
    s_addc_u32 s45, s35, 0
    s_add_u32 s46, s44, 0x40000
    s_addc_u32 s47, s45, 0
    s_lshl_b32 s8, s36, 2
    s_add_u32 s8, s8, s3
    s_lshl_b32 s8, s8, 4
    s_add_u32 s8, s8, s37
    s_mul_i32 s8, s8, 9216
    s_add_u32 s8, s8, 10489856
    s_add_u32 s10, s34, s8
    s_addc_u32 s11, s35, 0
    v_mov_b32 v216, -1
    v_mov_b32 v217, -1
    v_mov_b32 v218, -1
    v_mov_b32 v219, -1
    s_waitcnt lgkmcnt(0)
    s_waitcnt vmcnt(0)
    s_waitcnt lgkmcnt(0)
    s_barrier
    s_add_u32 m0, s58, 131072
    s_add_u32 s4, s50, 0
    s_addc_u32 s5, s51, 0
    global_load_lds_dwordx4 v3, s[4:5] sc1
    s_add_u32 m0, s58, 132096
    s_add_u32 s4, s50, 4096
    s_addc_u32 s5, s51, 0
    global_load_lds_dwordx4 v3, s[4:5] sc1
    s_add_u32 m0, s58, 133120
    s_add_u32 s4, s50, 8192
    s_addc_u32 s5, s51, 0
    global_load_lds_dwordx4 v3, s[4:5] sc1
    s_add_u32 m0, s58, 134144
    s_add_u32 s4, s50, 12288
    s_addc_u32 s5, s51, 0
    global_load_lds_dwordx4 v3, s[4:5] sc1
    s_add_u32 m0, s58, 147456
    s_add_u32 s4, s50, 16384
    s_addc_u32 s5, s51, 0
    global_load_lds_dwordx4 v3, s[4:5] sc1
    s_waitcnt vmcnt(4)
    s_add_u32 m0, s58, 148480
    s_add_u32 s4, s50, 20480
    s_addc_u32 s5, s51, 0
    global_load_lds_dwordx4 v3, s[4:5] sc1
    s_waitcnt vmcnt(4)
    s_add_u32 m0, s58, 149504
    s_add_u32 s4, s50, 24576
    s_addc_u32 s5, s51, 0
    global_load_lds_dwordx4 v3, s[4:5] sc1
    s_waitcnt vmcnt(4)
    s_add_u32 m0, s58, 0
    s_add_u32 s4, s50, 28672
    s_addc_u32 s5, s51, 0
    global_load_lds_dwordx4 v3, s[4:5] sc1
    s_waitcnt vmcnt(4)
    s_add_u32 m0, s58, 1024
    s_add_u32 s4, s50, 32768
    s_addc_u32 s5, s51, 0
    global_load_lds_dwordx4 v3, s[4:5] sc1
    s_waitcnt vmcnt(4)
    s_add_u32 m0, s58, 2048
    s_add_u32 s4, s50, 36864
    s_addc_u32 s5, s51, 0
    global_load_lds_dwordx4 v3, s[4:5] sc1
    s_waitcnt vmcnt(4)
    s_add_u32 m0, s58, 3072
    s_add_u32 s4, s50, 40960
    s_addc_u32 s5, s51, 0
    global_load_lds_dwordx4 v3, s[4:5] sc1
    s_waitcnt vmcnt(4)
    s_add_u32 m0, s58, 16384
    s_add_u32 s4, s50, 45056
    s_addc_u32 s5, s51, 0
    global_load_lds_dwordx4 v3, s[4:5] sc1
    s_waitcnt vmcnt(4)
    s_add_u32 m0, s58, 17408
    s_add_u32 s4, s50, 49152
    s_addc_u32 s5, s51, 0
    global_load_lds_dwordx4 v3, s[4:5] sc1
    s_waitcnt vmcnt(4)
    s_add_u32 m0, s58, 18432
    s_add_u32 s4, s50, 53248
    s_addc_u32 s5, s51, 0
    global_load_lds_dwordx4 v3, s[4:5] sc1
    s_waitcnt vmcnt(4)
    s_add_u32 m0, s58, 19456
    s_add_u32 s4, s50, 57344
    s_addc_u32 s5, s51, 0
    global_load_lds_dwordx4 v3, s[4:5] sc1
    s_waitcnt vmcnt(4)
    s_add_u32 m0, s58, 32768
    s_add_u32 s4, s50, 61440
    s_addc_u32 s5, s51, 0
    global_load_lds_dwordx4 v3, s[4:5] sc1
    s_waitcnt vmcnt(4)
    s_add_u32 m0, s58, 33792
    s_add_u32 s4, s50, 65536
    s_addc_u32 s5, s51, 0
    global_load_lds_dwordx4 v3, s[4:5] sc1
    s_waitcnt vmcnt(4)
    s_add_u32 m0, s58, 34816
    s_add_u32 s4, s50, 69632
    s_addc_u32 s5, s51, 0
    global_load_lds_dwordx4 v3, s[4:5] sc1
    s_waitcnt vmcnt(4)
    s_add_u32 m0, s58, 35840
    s_add_u32 s4, s50, 73728
    s_addc_u32 s5, s51, 0
    global_load_lds_dwordx4 v3, s[4:5] sc1
    global_store_dwordx4 v3, v[208:211], s[44:45] sc1
    global_store_dwordx4 v3, v[212:215], s[46:47] sc1
    s_waitcnt vmcnt(0)
    s_waitcnt lgkmcnt(0)
    s_barrier
    s_add_u32 m0, s58, 49152
    s_add_u32 s4, s50, 77824
    s_addc_u32 s5, s51, 0
    global_load_lds_dwordx4 v3, s[4:5] sc1
    s_add_u32 m0, s58, 50176
    s_add_u32 s4, s50, 81920
    s_addc_u32 s5, s51, 0
    global_load_lds_dwordx4 v3, s[4:5] sc1
    s_add_u32 m0, s58, 51200
    s_add_u32 s4, s50, 86016
    s_addc_u32 s5, s51, 0
    global_load_lds_dwordx4 v3, s[4:5] sc1
    s_add_u32 m0, s58, 52224
    s_add_u32 s4, s50, 90112
    s_addc_u32 s5, s51, 0
    global_load_lds_dwordx4 v3, s[4:5] sc1
    s_add_u32 m0, s58, 65536
    s_add_u32 s4, s50, 94208
    s_addc_u32 s5, s51, 0
    global_load_lds_dwordx4 v3, s[4:5] sc1
    s_waitcnt vmcnt(0)
    s_waitcnt lgkmcnt(0)
    s_barrier
    v_lshrrev_b32 v4, 3, v2
    v_mul_u32_u24 v12, 272, v4
    v_and_b32 v5, 7, v2
    v_lshl_add_u32 v12, v5, 5, v12
    s_mul_i32 s8, s41, 2176
    v_add_u32 v12, s8, v12
    v_lshlrev_b32 v13, 4, v5
    v_lshl_add_u32 v13, v4, 18, v13
    s_lshl_b32 s8, s32, 3
    s_add_u32 s8, s8, s41
    s_lshl_b32 s8, s8, 10
    s_lshl_b32 s9, s33, 7
    s_add_u32 s8, s8, s9
    s_add_u32 s44, s30, s8
    s_addc_u32 s45, s31, 0
    s_add_u32 s8, s8, 6291456
    s_add_u32 s46, s34, s8
    s_addc_u32 s47, s35, 0
    s_setprio 1
    s_add_u32 s10, s52, 3072
    s_addc_u32 s11, s53, 0
    s_add_u32 s12, s52, 12288
    s_addc_u32 s13, s53, 0
    s_add_u32 s50, s52, 21504
    s_addc_u32 s51, s53, 0
    s_add_u32 s54, s52, 30720
    s_addc_u32 s55, s53, 0
    v_add_u32 v19, 147456, v3
    v_add_u32 v17, 0x10000, v6
    v_add_u32 v18, 0x20000, v6
    s_add_u32 s4, s62, 24576
    s_addc_u32 s5, s63, 0
    s_add_u32 m0, s58, 64512
    s_nop 0
    global_load_lds_dwordx4 v3, s[4:5] offset:2048 sc1
    s_add_u32 m0, s58, 64512
    s_nop 0
    global_load_lds_dwordx4 v3, s[4:5] offset:3072 sc1
    s_add_u32 s4, s62, 28672
    s_addc_u32 s5, s63, 0
    s_add_u32 m0, s58, 68608
    s_nop 0
    global_load_lds_dwordx4 v3, s[4:5] offset:0 sc1
    s_add_u32 m0, s58, 80896
    s_nop 0
    global_load_lds_dwordx4 v3, s[4:5] offset:1024 sc1
    s_add_u32 m0, s58, 80896
    s_nop 0
    global_load_lds_dwordx4 v3, s[4:5] offset:2048 sc1
    s_add_u32 m0, s58, 80896
    s_nop 0
    global_load_lds_dwordx4 v3, s[4:5] offset:3072 sc1
    s_add_u32 s4, s62, 32768
    s_addc_u32 s5, s63, 0
    s_add_u32 m0, s58, 84992
    s_nop 0
    global_load_lds_dwordx4 v3, s[4:5] offset:0 sc1
    s_add_u32 m0, s58, 97280
    s_nop 0
    global_load_lds_dwordx4 v3, s[4:5] offset:1024 sc1
    s_mov_b32 s15, 16777216
Lsp37:
    ds_read_b32 v14, v7 offset:16
    s_sub_u32 s15, s15, 1
    s_cbranch_scc1 L_end
    s_waitcnt lgkmcnt(0)
    v_cmp_gt_u32 vcc, 4, v14
    s_sleep 2
    s_cbranch_vccnz Lsp37
    global_load_dwordx4 v[8:11], v16, s[48:49] offset:0 sc1
    s_add_u32 m0, s58, 97280
    s_nop 0
    global_load_lds_dwordx4 v3, s[4:5] offset:2048 sc1
    s_add_u32 m0, s58, 97280
    s_nop 0
    global_load_lds_dwordx4 v3, s[4:5] offset:3072 sc1
    s_add_u32 s4, s62, 36864
    s_addc_u32 s5, s63, 0
    s_add_u32 m0, s58, 101376
    s_nop 0
    global_load_lds_dwordx4 v3, s[4:5] offset:0 sc1
    s_add_u32 m0, s58, 113664
    s_nop 0
    global_load_lds_dwordx4 v3, s[4:5] offset:1024 sc1
    s_add_u32 m0, s58, 113664
    s_nop 0
    global_load_lds_dwordx4 v3, s[4:5] offset:2048 sc1
    s_add_u32 m0, s58, 113664
    s_nop 0
    global_load_lds_dwordx4 v3, s[4:5] offset:3072 sc1
    s_add_u32 s4, s62, 40960
    s_addc_u32 s5, s63, 0
    s_add_u32 m0, s58, 117760
    s_nop 0
    global_load_lds_dwordx4 v3, s[4:5] offset:0 sc1
    s_add_u32 m0, s58, 130048
    s_nop 0
    global_load_lds_dwordx4 v3, s[4:5] offset:1024 sc1
    s_add_u32 m0, s58, 130048
    s_nop 0
    global_load_lds_dwordx4 v3, s[4:5] offset:2048 sc1
    s_add_u32 m0, s58, 130048
    s_nop 0
    global_load_lds_dwordx4 v3, s[4:5] offset:3072 sc1
    s_waitcnt vmcnt(10)
    v_and_b32 v4, v9, v11
    v_or_b32 v5, v9, v11
    v_xor_b32 v4, s40, v4
    v_xor_b32 v5, s40, v5
    v_or_b32 v4, v4, v5
    v_cmp_ne_u32 vcc, 0, v4
    s_cbranch_vccnz Lpoll38
Lok39:
    global_load_dwordx4 v[192:195], v3, s[10:11] offset:-3072 sc1
    global_load_dwordx4 v[196:199], v19, s[10:11] offset:-3072 sc1
    global_load_dwordx4 v[200:203], v3, s[12:13] offset:-3072 sc1
    global_load_dwordx4 v[204:207], v19, s[12:13] offset:-3072 sc1
    global_load_dwordx4 v[208:211], v3, s[50:51] offset:-3072 sc1
    global_load_dwordx4 v[212:215], v19, s[50:51] offset:-3072 sc1
    global_load_dwordx4 v[216:219], v3, s[54:55] offset:-3072 sc1
    global_load_dwordx4 v[220:223], v19, s[54:55] offset:-3072 sc1
    global_load_dwordx4 v[224:227], v3, s[10:11] offset:-2048 sc1
    global_load_dwordx4 v[228:231], v19, s[10:11] offset:-2048 sc1
    global_load_dwordx4 v[232:235], v3, s[12:13] offset:-2048 sc1
    global_load_dwordx4 v[236:239], v19, s[12:13] offset:-2048 sc1
    global_load_dwordx4 v[240:243], v3, s[50:51] offset:-2048 sc1
    global_load_dwordx4 v[244:247], v19, s[50:51] offset:-2048 sc1
    global_load_dwordx4 v[248:251], v3, s[54:55] offset:-2048 sc1
    global_load_dwordx4 v[252:255], v19, s[54:55] offset:-2048 sc1
    s_waitcnt lgkmcnt(0)
    s_waitcnt vmcnt(14)
    v_mfma_f32_32x32x16_bf16 v[24:39], v[88:91], v[192:195], 0
    v_mfma_f32_32x32x16_bf16 v[40:55], v[88:91], v[196:199], 0
    v_mfma_f32_32x32x16_bf16 v[56:71], v[92:95], v[192:195], 0
    v_mfma_f32_32x32x16_bf16 v[72:87], v[92:95], v[196:199], 0
    s_waitcnt vmcnt(12)
    v_mfma_f32_32x32x16_bf16 v[24:39], v[96:99], v[200:203], v[24:39]
    v_mfma_f32_32x32x16_bf16 v[40:55], v[96:99], v[204:207], v[40:55]
    v_mfma_f32_32x32x16_bf16 v[56:71], v[100:103], v[200:203], v[56:71]
    v_mfma_f32_32x32x16_bf16 v[72:87], v[100:103], v[204:207], v[72:87]
    s_mov_b32 s15, 16777216
Lsp40:
    ds_read_b32 v14, v7 offset:16
    s_sub_u32 s15, s15, 1
    s_cbranch_scc1 L_end
    s_waitcnt lgkmcnt(0)
    v_cmp_gt_u32 vcc, 8, v14
    s_sleep 2
    s_cbranch_vccnz Lsp40
    global_load_dwordx4 v[8:11], v16, s[48:49] offset:128 sc1
    s_waitcnt vmcnt(11)
    v_mfma_f32_32x32x16_bf16 v[24:39], v[104:107], v[208:211], v[24:39]
    v_mfma_f32_32x32x16_bf16 v[40:55], v[104:107], v[212:215], v[40:55]
    v_mfma_f32_32x32x16_bf16 v[56:71], v[108:111], v[208:211], v[56:71]
    v_mfma_f32_32x32x16_bf16 v[72:87], v[108:111], v[212:215], v[72:87]
    s_waitcnt vmcnt(9)
    v_mfma_f32_32x32x16_bf16 v[24:39], v[112:115], v[216:219], v[24:39]
    v_mfma_f32_32x32x16_bf16 v[40:55], v[112:115], v[220:223], v[40:55]
    v_mfma_f32_32x32x16_bf16 v[56:71], v[116:119], v[216:219], v[56:71]
    v_mfma_f32_32x32x16_bf16 v[72:87], v[116:119], v[220:223], v[72:87]
    s_waitcnt vmcnt(0)
    v_and_b32 v4, v9, v11
    v_or_b32 v5, v9, v11
    v_xor_b32 v4, s40, v4
    v_xor_b32 v5, s40, v5
    v_or_b32 v4, v4, v5
    v_cmp_ne_u32 vcc, 0, v4
    s_cbranch_vccnz Lpoll41
Lok42:
    global_load_dwordx4 v[88:91], v3, s[10:11] offset:-1024 sc1
    global_load_dwordx4 v[92:95], v19, s[10:11] offset:-1024 sc1
    global_load_dwordx4 v[192:195], v3, s[12:13] offset:-1024 sc1
    global_load_dwordx4 v[196:199], v19, s[12:13] offset:-1024 sc1
    global_load_dwordx4 v[96:99], v3, s[50:51] offset:-1024 sc1
    global_load_dwordx4 v[100:103], v19, s[50:51] offset:-1024 sc1
    global_load_dwordx4 v[200:203], v3, s[54:55] offset:-1024 sc1
    global_load_dwordx4 v[204:207], v19, s[54:55] offset:-1024 sc1
    global_load_dwordx4 v[104:107], v3, s[10:11] offset:0 sc1
    global_load_dwordx4 v[108:111], v19, s[10:11] offset:0 sc1
    global_load_dwordx4 v[208:211], v3, s[12:13] offset:0 sc1
    global_load_dwordx4 v[212:215], v19, s[12:13] offset:0 sc1
    global_load_dwordx4 v[112:115], v3, s[50:51] offset:0 sc1
    global_load_dwordx4 v[116:119], v19, s[50:51] offset:0 sc1
    global_load_dwordx4 v[216:219], v3, s[54:55] offset:0 sc1
    global_load_dwordx4 v[220:223], v19, s[54:55] offset:0 sc1
    v_mfma_f32_32x32x16_bf16 v[24:39], v[120:123], v[224:227], v[24:39]
    v_mfma_f32_32x32x16_bf16 v[40:55], v[120:123], v[228:231], v[40:55]
    v_mfma_f32_32x32x16_bf16 v[56:71], v[124:127], v[224:227], v[56:71]
    v_mfma_f32_32x32x16_bf16 v[72:87], v[124:127], v[228:231], v[72:87]
    v_mfma_f32_32x32x16_bf16 v[24:39], v[128:131], v[232:235], v[24:39]
    v_mfma_f32_32x32x16_bf16 v[40:55], v[128:131], v[236:239], v[40:55]
    v_mfma_f32_32x32x16_bf16 v[56:71], v[132:135], v[232:235], v[56:71]
    v_mfma_f32_32x32x16_bf16 v[72:87], v[132:135], v[236:239], v[72:87]
    s_mov_b32 s15, 16777216
Lsp43:
    ds_read_b32 v14, v7 offset:4
    s_sub_u32 s15, s15, 1
    s_cbranch_scc1 L_end
    s_waitcnt lgkmcnt(0)
    v_cmp_gt_u32 vcc, 8, v14
    s_sleep 2
    s_cbranch_vccnz Lsp43
    global_load_dwordx4 v[120:123], v3, s[10:11] offset:1024 sc1
    global_load_dwordx4 v[124:127], v19, s[10:11] offset:1024 sc1
    global_load_dwordx4 v[224:227], v3, s[12:13] offset:1024 sc1
    global_load_dwordx4 v[228:231], v19, s[12:13] offset:1024 sc1
    global_load_dwordx4 v[128:131], v3, s[50:51] offset:1024 sc1
    global_load_dwordx4 v[132:135], v19, s[50:51] offset:1024 sc1
    global_load_dwordx4 v[232:235], v3, s[54:55] offset:1024 sc1
    global_load_dwordx4 v[236:239], v19, s[54:55] offset:1024 sc1
    v_mfma_f32_32x32x16_bf16 v[24:39], v[136:139], v[240:243], v[24:39]
    v_mfma_f32_32x32x16_bf16 v[40:55], v[136:139], v[244:247], v[40:55]
    v_mfma_f32_32x32x16_bf16 v[56:71], v[140:143], v[240:243], v[56:71]
    v_mfma_f32_32x32x16_bf16 v[72:87], v[140:143], v[244:247], v[72:87]
    v_mfma_f32_32x32x16_bf16 v[24:39], v[144:147], v[248:251], v[24:39]
    v_mfma_f32_32x32x16_bf16 v[40:55], v[144:147], v[252:255], v[40:55]
    v_mfma_f32_32x32x16_bf16 v[56:71], v[148:151], v[248:251], v[56:71]
    v_mfma_f32_32x32x16_bf16 v[72:87], v[148:151], v[252:255], v[72:87]
    ds_read_b128 v[136:139], v17 offset:1024
    ds_read_b128 v[140:143], v17 offset:2048
    ds_read_b128 v[240:243], v17 offset:3072
    ds_read_b128 v[244:247], v17 offset:16384
    s_waitcnt vmcnt(22)
    v_mfma_f32_32x32x16_bf16 v[24:39], v[152:155], v[88:91], v[24:39]
    v_mfma_f32_32x32x16_bf16 v[40:55], v[152:155], v[92:95], v[40:55]
    v_mfma_f32_32x32x16_bf16 v[56:71], v[156:159], v[88:91], v[56:71]
    v_mfma_f32_32x32x16_bf16 v[72:87], v[156:159], v[92:95], v[72:87]
    ds_read_b128 v[144:147], v17 offset:17408
    ds_read_b128 v[148:151], v17 offset:18432
    s_waitcnt vmcnt(20)
    v_mfma_f32_32x32x16_bf16 v[24:39], v[160:163], v[192:195], v[24:39]
    v_mfma_f32_32x32x16_bf16 v[40:55], v[160:163], v[196:199], v[40:55]
    v_mfma_f32_32x32x16_bf16 v[56:71], v[164:167], v[192:195], v[56:71]
    v_mfma_f32_32x32x16_bf16 v[72:87], v[164:167], v[196:199], v[72:87]
    ds_read_b128 v[248:251], v17 offset:19456
    ds_read_b128 v[252:255], v17 offset:32768
    s_mov_b32 s15, 16777216
Lsp44:
    ds_read_b32 v14, v7 offset:4
    s_sub_u32 s15, s15, 1
    s_cbranch_scc1 L_end
    s_waitcnt lgkmcnt(0)
    v_cmp_gt_u32 vcc, 12, v14
    s_sleep 2
    s_cbranch_vccnz Lsp44
    s_waitcnt vmcnt(18)
    v_mfma_f32_32x32x16_bf16 v[24:39], v[168:171], v[96:99], v[24:39]
    v_mfma_f32_32x32x16_bf16 v[40:55], v[168:171], v[100:103], v[40:55]
    v_mfma_f32_32x32x16_bf16 v[56:71], v[172:175], v[96:99], v[56:71]
    v_mfma_f32_32x32x16_bf16 v[72:87], v[172:175], v[100:103], v[72:87]
    global_load_dwordx4 v[152:155], v3, s[10:11] offset:2048 sc1
    global_load_dwordx4 v[156:159], v19, s[10:11] offset:2048 sc1
    global_load_dwordx4 v[88:91], v3, s[12:13] offset:2048 sc1
    global_load_dwordx4 v[92:95], v19, s[12:13] offset:2048 sc1
    s_waitcnt vmcnt(20)
    v_mfma_f32_32x32x16_bf16 v[24:39], v[176:179], v[200:203], v[24:39]
    v_mfma_f32_32x32x16_bf16 v[40:55], v[176:179], v[204:207], v[40:55]
    v_mfma_f32_32x32x16_bf16 v[56:71], v[180:183], v[200:203], v[56:71]
    v_mfma_f32_32x32x16_bf16 v[72:87], v[180:183], v[204:207], v[72:87]
    global_load_dwordx4 v[160:163], v3, s[50:51] offset:2048 sc1
    global_load_dwordx4 v[164:167], v19, s[50:51] offset:2048 sc1
    global_load_dwordx4 v[192:195], v3, s[54:55] offset:2048 sc1
    global_load_dwordx4 v[196:199], v19, s[54:55] offset:2048 sc1
    s_waitcnt vmcnt(22)
    v_mfma_f32_32x32x16_bf16 v[24:39], v[184:187], v[104:107], v[24:39]
    v_mfma_f32_32x32x16_bf16 v[40:55], v[184:187], v[108:111], v[40:55]
    v_mfma_f32_32x32x16_bf16 v[56:71], v[188:191], v[104:107], v[56:71]
    v_mfma_f32_32x32x16_bf16 v[72:87], v[188:191], v[108:111], v[72:87]
    ds_read_b128 v[168:171], v17 offset:33792
    ds_read_b128 v[172:175], v17 offset:34816
    ds_read_b128 v[96:99], v17 offset:35840
    ds_read_b128 v[100:103], v17 offset:49152
    s_waitcnt vmcnt(20)
    s_waitcnt lgkmcnt(10)
    v_mfma_f32_32x32x16_bf16 v[24:39], v[136:139], v[208:211], v[24:39]
    v_mfma_f32_32x32x16_bf16 v[40:55], v[136:139], v[212:215], v[40:55]
    v_mfma_f32_32x32x16_bf16 v[56:71], v[140:143], v[208:211], v[56:71]
    v_mfma_f32_32x32x16_bf16 v[72:87], v[140:143], v[212:215], v[72:87]
    ds_read_b128 v[176:179], v17 offset:50176
    ds_read_b128 v[180:183], v17 offset:51200
    ds_read_b128 v[200:203], v17 offset:52224
    ds_read_b128 v[204:207], v18 offset:0
    s_waitcnt vmcnt(18)
    s_waitcnt lgkmcnt(12)
    v_mfma_f32_32x32x16_bf16 v[24:39], v[240:243], v[112:115], v[24:39]
    v_mfma_f32_32x32x16_bf16 v[40:55], v[240:243], v[116:119], v[40:55]
    v_mfma_f32_32x32x16_bf16 v[56:71], v[244:247], v[112:115], v[56:71]
    v_mfma_f32_32x32x16_bf16 v[72:87], v[244:247], v[116:119], v[72:87]
    ds_read_b128 v[184:187], v18 offset:1024
    ds_read_b128 v[188:191], v18 offset:2048
    s_add_u32 s42, s62, 45056
    s_addc_u32 s43, s63, 0
    global_load_dwordx4 v[104:107], v3, s[42:43] offset:0 sc1
    global_load_dwordx4 v[108:111], v3, s[42:43] offset:1024 sc1
    s_waitcnt vmcnt(18)
    s_waitcnt lgkmcnt(12)
    v_mfma_f32_32x32x16_bf16 v[24:39], v[144:147], v[216:219], v[24:39]
    v_mfma_f32_32x32x16_bf16 v[40:55], v[144:147], v[220:223], v[40:55]
    v_mfma_f32_32x32x16_bf16 v[56:71], v[148:151], v[216:219], v[56:71]
    v_mfma_f32_32x32x16_bf16 v[72:87], v[148:151], v[220:223], v[72:87]
    global_load_dwordx4 v[136:139], v3, s[10:11] offset:3072 sc1
    global_load_dwordx4 v[140:143], v19, s[10:11] offset:3072 sc1
    global_load_dwordx4 v[208:211], v3, s[12:13] offset:3072 sc1
    global_load_dwordx4 v[212:215], v19, s[12:13] offset:3072 sc1
    s_waitcnt vmcnt(20)
    v_max3_u32 v4, v121, v123, v125
    v_max_u32 v4, v4, v127
    v_cmp_le_u32 vcc, 0xffff0000, v4
    s_cbranch_vccnz Lpoll45
Lok46:
    s_waitcnt lgkmcnt(10)
    v_mfma_f32_32x32x16_bf16 v[24:39], v[248:251], v[120:123], v[24:39]
    v_mfma_f32_32x32x16_bf16 v[40:55], v[248:251], v[124:127], v[40:55]
    v_mfma_f32_32x32x16_bf16 v[56:71], v[252:255], v[120:123], v[56:71]
    v_mfma_f32_32x32x16_bf16 v[72:87], v[252:255], v[124:127], v[72:87]
    global_load_dwordx4 v[240:243], v3, s[50:51] offset:3072 sc1
    global_load_dwordx4 v[244:247], v19, s[50:51] offset:3072 sc1
    global_load_dwordx4 v[112:115], v3, s[54:55] offset:3072 sc1
    global_load_dwordx4 v[116:119], v19, s[54:55] offset:3072 sc1
    s_waitcnt vmcnt(22)
    v_max3_u32 v4, v225, v227, v229
    v_max_u32 v4, v4, v231
    v_cmp_le_u32 vcc, 0xffff0000, v4
    s_cbranch_vccnz Lpoll47
Lok48:
    s_waitcnt lgkmcnt(8)
    v_mfma_f32_32x32x16_bf16 v[24:39], v[168:171], v[224:227], v[24:39]
    v_mfma_f32_32x32x16_bf16 v[40:55], v[168:171], v[228:231], v[40:55]
    v_mfma_f32_32x32x16_bf16 v[56:71], v[172:175], v[224:227], v[56:71]
    v_mfma_f32_32x32x16_bf16 v[72:87], v[172:175], v[228:231], v[72:87]
    global_load_dwordx4 v[144:147], v3, s[42:43] offset:2048 sc1
    global_load_dwordx4 v[148:151], v3, s[42:43] offset:3072 sc1
    s_add_u32 s42, s62, 53248
    s_addc_u32 s43, s63, 0
    global_load_dwordx4 v[216:219], v3, s[42:43] offset:-4096 sc1
    global_load_dwordx4 v[220:223], v3, s[42:43] offset:-3072 sc1
    s_waitcnt vmcnt(24)
    v_max3_u32 v4, v129, v131, v133
    v_max_u32 v4, v4, v135
    v_cmp_le_u32 vcc, 0xffff0000, v4
    s_cbranch_vccnz Lpoll49
Lok50:
    s_waitcnt lgkmcnt(6)
    v_mfma_f32_32x32x16_bf16 v[24:39], v[96:99], v[128:131], v[24:39]
    v_mfma_f32_32x32x16_bf16 v[40:55], v[96:99], v[132:135], v[40:55]
    v_mfma_f32_32x32x16_bf16 v[56:71], v[100:103], v[128:131], v[56:71]
    v_mfma_f32_32x32x16_bf16 v[72:87], v[100:103], v[132:135], v[72:87]
    global_load_dwordx4 v[248:251], v3, s[42:43] offset:-2048 sc1
    global_load_dwordx4 v[252:255], v3, s[42:43] offset:-1024 sc1
    global_load_dwordx4 v[120:123], v3, s[42:43] offset:0 sc1
    global_load_dwordx4 v[124:127], v3, s[42:43] offset:1024 sc1
    s_waitcnt vmcnt(26)
    v_max3_u32 v4, v233, v235, v237
    v_max_u32 v4, v4, v239
    v_cmp_le_u32 vcc, 0xffff0000, v4
    s_cbranch_vccnz Lpoll51
Lok52:
    s_waitcnt lgkmcnt(4)
    v_mfma_f32_32x32x16_bf16 v[24:39], v[176:179], v[232:235], v[24:39]
    v_mfma_f32_32x32x16_bf16 v[40:55], v[176:179], v[236:239], v[40:55]
    v_mfma_f32_32x32x16_bf16 v[56:71], v[180:183], v[232:235], v[56:71]
    v_mfma_f32_32x32x16_bf16 v[72:87], v[180:183], v[236:239], v[72:87]
    global_load_dwordx4 v[168:171], v3, s[42:43] offset:2048 sc1
    global_load_dwordx4 v[172:175], v3, s[42:43] offset:3072 sc1
    s_waitcnt vmcnt(26)
    v_max3_u32 v4, v153, v155, v157
    v_max_u32 v4, v4, v159
    v_cmp_le_u32 vcc, 0xffff0000, v4
    s_cbranch_vccnz Lpoll53
Lok54:
    s_waitcnt lgkmcnt(2)
    v_mfma_f32_32x32x16_bf16 v[24:39], v[200:203], v[152:155], v[24:39]
    v_mfma_f32_32x32x16_bf16 v[40:55], v[200:203], v[156:159], v[40:55]
    v_mfma_f32_32x32x16_bf16 v[56:71], v[204:207], v[152:155], v[56:71]
    v_mfma_f32_32x32x16_bf16 v[72:87], v[204:207], v[156:159], v[72:87]
    s_waitcnt vmcnt(24)
    v_max3_u32 v4, v89, v91, v93
    v_max_u32 v4, v4, v95
    v_cmp_le_u32 vcc, 0xffff0000, v4
    s_cbranch_vccnz Lpoll55
Lok56:
    s_waitcnt lgkmcnt(0)
    v_mfma_f32_32x32x16_bf16 v[24:39], v[184:187], v[88:91], v[24:39]
    v_mfma_f32_32x32x16_bf16 v[40:55], v[184:187], v[92:95], v[40:55]
    v_mfma_f32_32x32x16_bf16 v[56:71], v[188:191], v[88:91], v[56:71]
    v_mfma_f32_32x32x16_bf16 v[72:87], v[188:191], v[92:95], v[72:87]
    s_waitcnt vmcnt(18)
    v_max3_u32 v4, v161, v163, v165
    v_max_u32 v4, v4, v167
    v_cmp_le_u32 vcc, 0xffff0000, v4
    s_cbranch_vccnz Lpoll57
Lok58:
    s_nop 0
    v_mfma_f32_32x32x16_bf16 v[24:39], v[104:107], v[160:163], v[24:39]
    v_mfma_f32_32x32x16_bf16 v[40:55], v[104:107], v[164:167], v[40:55]
    v_mfma_f32_32x32x16_bf16 v[56:71], v[108:111], v[160:163], v[56:71]
    v_mfma_f32_32x32x16_bf16 v[72:87], v[108:111], v[164:167], v[72:87]
    s_waitcnt vmcnt(8)
    v_max3_u32 v4, v193, v195, v197
    v_max_u32 v4, v4, v199
    v_cmp_le_u32 vcc, 0xffff0000, v4
    s_cbranch_vccnz Lpoll59
Lok60:
    s_nop 0
    v_mfma_f32_32x32x16_bf16 v[24:39], v[144:147], v[192:195], v[24:39]
    v_mfma_f32_32x32x16_bf16 v[40:55], v[144:147], v[196:199], v[40:55]
    v_mfma_f32_32x32x16_bf16 v[56:71], v[148:151], v[192:195], v[56:71]
    v_mfma_f32_32x32x16_bf16 v[72:87], v[148:151], v[196:199], v[72:87]
    s_waitcnt lgkmcnt(0)
    s_barrier
    global_load_dwordx4 v[8:11], v13, s[46:47] sc1
    s_waitcnt vmcnt(7)
    v_max3_u32 v4, v137, v139, v141
    v_max_u32 v4, v4, v143
    v_cmp_le_u32 vcc, 0xffff0000, v4
    s_cbranch_vccnz Lpoll61
Lok62:
    s_nop 0
    v_mfma_f32_32x32x16_bf16 v[24:39], v[216:219], v[136:139], v[24:39]
    s_waitcnt vmcnt(5)
    v_max3_u32 v4, v209, v211, v213
    v_max_u32 v4, v4, v215
    v_cmp_le_u32 vcc, 0xffff0000, v4
    s_cbranch_vccnz Lpoll63
Lok64:
    s_nop 0
    v_mfma_f32_32x32x16_bf16 v[24:39], v[248:251], v[208:211], v[24:39]
    s_waitcnt vmcnt(3)
    v_max3_u32 v4, v241, v243, v245
    v_max_u32 v4, v4, v247
    v_cmp_le_u32 vcc, 0xffff0000, v4
    s_cbranch_vccnz Lpoll65
Lok66:
    s_nop 0
    v_mfma_f32_32x32x16_bf16 v[24:39], v[120:123], v[240:243], v[24:39]
    s_waitcnt vmcnt(1)
    v_max3_u32 v4, v113, v115, v117
    v_max_u32 v4, v4, v119
    v_cmp_le_u32 vcc, 0xffff0000, v4
    s_cbranch_vccnz Lpoll67
Lok68:
    s_nop 0
    v_mfma_f32_32x32x16_bf16 v[24:39], v[168:171], v[112:115], v[24:39]
    v_mfma_f32_32x32x16_bf16 v[40:55], v[216:219], v[140:143], v[40:55]
    v_mfma_f32_32x32x16_bf16 v[40:55], v[248:251], v[212:215], v[40:55]
    s_nop 9
    ds_write_b128 v15, v[24:27] offset:0
    v_mfma_f32_32x32x16_bf16 v[40:55], v[120:123], v[244:247], v[40:55]
    ds_write_b128 v15, v[28:31] offset:32
    v_mfma_f32_32x32x16_bf16 v[40:55], v[168:171], v[116:119], v[40:55]
    ds_write_b128 v15, v[32:35] offset:64
    ds_write_b128 v15, v[36:39] offset:96
    v_mfma_f32_32x32x16_bf16 v[56:71], v[220:223], v[136:139], v[56:71]
    v_mfma_f32_32x32x16_bf16 v[56:71], v[252:255], v[208:211], v[56:71]
    s_nop 7
    ds_write_b128 v15, v[40:43] offset:8704
    v_mfma_f32_32x32x16_bf16 v[56:71], v[124:127], v[240:243], v[56:71]
    ds_write_b128 v15, v[44:47] offset:8736
    v_mfma_f32_32x32x16_bf16 v[56:71], v[172:175], v[112:115], v[56:71]
    ds_write_b128 v15, v[48:51] offset:8768
    ds_write_b128 v15, v[52:55] offset:8800
    v_mfma_f32_32x32x16_bf16 v[72:87], v[220:223], v[140:143], v[72:87]
    v_mfma_f32_32x32x16_bf16 v[72:87], v[252:255], v[212:215], v[72:87]
    s_nop 7
    ds_write_b128 v15, v[56:59] offset:128
    v_mfma_f32_32x32x16_bf16 v[72:87], v[124:127], v[244:247], v[72:87]
    ds_write_b128 v15, v[60:63] offset:160
    v_mfma_f32_32x32x16_bf16 v[72:87], v[172:175], v[116:119], v[72:87]
    ds_write_b128 v15, v[64:67] offset:192
    ds_write_b128 v15, v[68:71] offset:224
    s_nop 9
    ds_write_b128 v15, v[72:75] offset:8832
    ds_write_b128 v15, v[76:79] offset:8864
    ds_write_b128 v15, v[80:83] offset:8896
    ds_write_b128 v15, v[84:87] offset:8928
    s_waitcnt lgkmcnt(0)
    s_waitcnt vmcnt(0)
    v_lshlrev_b32 v160, 16, v8
    v_and_b32 v161, 0xffff0000, v8
    v_lshlrev_b32 v162, 16, v9
    v_and_b32 v163, 0xffff0000, v9
    v_lshlrev_b32 v164, 16, v10
    v_and_b32 v165, 0xffff0000, v10
    v_lshlrev_b32 v166, 16, v11
    v_and_b32 v167, 0xffff0000, v11
    s_barrier
    ds_read_b128 v[88:91], v12 offset:0
    ds_read_b128 v[92:95], v12 offset:17408
    ds_read_b128 v[96:99], v12 offset:34816
    ds_read_b128 v[100:103], v12 offset:52224
    ds_read_b128 v[120:123], v12 offset:16
    ds_read_b128 v[124:127], v12 offset:17424
    ds_read_b128 v[128:131], v12 offset:34832
    ds_read_b128 v[132:135], v12 offset:52240
    s_waitcnt lgkmcnt(4)
    v_pk_add_f32 v[88:89], v[88:89], v[92:93]
    v_pk_add_f32 v[96:97], v[96:97], v[100:101]
    v_pk_add_f32 v[90:91], v[90:91], v[94:95]
    v_pk_add_f32 v[98:99], v[98:99], v[102:103]
    v_pk_add_f32 v[88:89], v[88:89], v[96:97]
    v_pk_add_f32 v[90:91], v[90:91], v[98:99]
    v_cvt_pk_bf16_f32 v89, v88, v89
    v_cvt_pk_bf16_f32 v91, v90, v91
    v_lshlrev_b32 v88, 16, v89
    v_and_b32 v89, 0xffff0000, v89
    v_lshlrev_b32 v90, 16, v91
    v_and_b32 v91, 0xffff0000, v91
    v_pk_add_f32 v[88:89], v[88:89], v[160:161]
    v_pk_add_f32 v[90:91], v[90:91], v[162:163]
    v_cvt_pk_bf16_f32 v152, v88, v89
    v_cvt_pk_bf16_f32 v153, v90, v91
    s_waitcnt lgkmcnt(0)
    v_pk_add_f32 v[120:121], v[120:121], v[124:125]
    v_pk_add_f32 v[128:129], v[128:129], v[132:133]
    v_pk_add_f32 v[122:123], v[122:123], v[126:127]
    v_pk_add_f32 v[130:131], v[130:131], v[134:135]
    v_pk_add_f32 v[120:121], v[120:121], v[128:129]
    v_pk_add_f32 v[122:123], v[122:123], v[130:131]
    v_cvt_pk_bf16_f32 v121, v120, v121
    v_cvt_pk_bf16_f32 v123, v122, v123
    v_lshlrev_b32 v120, 16, v121
    v_and_b32 v121, 0xffff0000, v121
    v_lshlrev_b32 v122, 16, v123
    v_and_b32 v123, 0xffff0000, v123
    v_pk_add_f32 v[120:121], v[120:121], v[164:165]
    v_pk_add_f32 v[122:123], v[122:123], v[166:167]
    v_cvt_pk_bf16_f32 v154, v120, v121
    v_cvt_pk_bf16_f32 v155, v122, v123
    global_store_dwordx4 v13, v[152:155], s[44:45] sc1
    s_endpgm
Lpoll3:
    s_mov_b32 s15, 1048576
    s_mov_b64 exec, vcc
Lpoll3r:
    s_sleep 2
    global_load_dwordx4 v[140:143], v228, s[4:5] sc1
    global_load_dwordx4 v[144:147], v229, s[4:5] sc1
    global_load_dwordx4 v[148:151], v228, s[6:7] sc1
    global_load_dwordx4 v[152:155], v229, s[6:7] sc1
    s_sub_u32 s15, s15, 1
    s_cbranch_scc1 L_end
    s_waitcnt vmcnt(0)
    v_and_b32 v5, v141, v143
    v_or_b32 v6, v141, v143
    v_bitop3_b32 v5, v5, v145, v147 bitop3:0x80
    v_or3_b32 v6, v6, v145, v147
    v_bitop3_b32 v5, v5, v149, v151 bitop3:0x80
    v_or3_b32 v6, v6, v149, v151
    v_bitop3_b32 v5, v5, v153, v155 bitop3:0x80
    v_or3_b32 v6, v6, v153, v155
    v_xor_b32 v5, s40, v5
    v_xor_b32 v6, s40, v6
    v_or_b32 v5, v5, v6
    v_cmpx_ne_u32 vcc, 0, v5
    s_cbranch_execnz Lpoll3r
    s_mov_b64 exec, -1
    s_branch Lok4
Lpoll7:
    s_mov_b32 s15, 1048576
    s_mov_b64 exec, vcc
Lpoll7r:
    s_sleep 2
    global_load_dwordx4 v[148:151], v240, s[4:5] sc1
    global_load_dwordx4 v[152:155], v240, s[6:7] sc1
    s_sub_u32 s15, s15, 1
    s_cbranch_scc1 L_end
    s_waitcnt vmcnt(0)
    v_max3_u32 v5, v149, v151, v153
    v_max_u32 v5, v5, v155
    v_cmpx_le_u32 vcc, 0xffff0000, v5
    s_cbranch_execnz Lpoll7r
    s_mov_b64 exec, -1
    s_branch Lok8
Lpoll10:
    s_mov_b32 s15, 1048576
    s_mov_b64 exec, vcc
Lpoll10r:
    s_sleep 2
    global_load_dwordx4 v[116:119], v3, s[4:5] offset:0 sc1
    global_load_dwordx4 v[120:123], v3, s[4:5] offset:128 sc1
    global_load_dwordx4 v[124:127], v3, s[4:5] offset:256 sc1
    global_load_dwordx4 v[128:131], v3, s[4:5] offset:384 sc1
    global_load_dwordx4 v[132:135], v3, s[4:5] offset:512 sc1
    global_load_dwordx4 v[136:139], v3, s[4:5] offset:640 sc1
    global_load_dwordx4 v[140:143], v3, s[4:5] offset:768 sc1
    global_load_dwordx4 v[144:147], v3, s[4:5] offset:896 sc1
    global_load_dwordx4 v[180:183], v3, s[4:5] offset:2048 sc1
    s_sub_u32 s15, s15, 1
    s_cbranch_scc1 L_end
    s_waitcnt vmcnt(0)
    v_max3_u32 v5, v117, v119, v121
    v_max3_u32 v5, v5, v123, v125
    v_max3_u32 v5, v5, v127, v129
    v_max3_u32 v5, v5, v131, v133
    v_max3_u32 v5, v5, v135, v137
    v_max3_u32 v5, v5, v139, v141
    v_max3_u32 v5, v5, v143, v145
    v_max3_u32 v5, v5, v147, v181
    v_max_u32 v5, v5, v183
    v_cmpx_le_u32 vcc, 0xffff0000, v5
    s_cbranch_execnz Lpoll10r
    s_mov_b64 exec, -1
    s_branch Lok11
Lpoll12:
    s_mov_b32 s15, 1048576
    s_mov_b64 exec, vcc
Lpoll12r:
    s_sleep 2
    global_load_dwordx4 v[148:151], v3, s[4:5] offset:1024 sc1
    global_load_dwordx4 v[152:155], v3, s[4:5] offset:1152 sc1
    global_load_dwordx4 v[156:159], v3, s[4:5] offset:1280 sc1
    global_load_dwordx4 v[160:163], v3, s[4:5] offset:1408 sc1
    s_sub_u32 s15, s15, 1
    s_cbranch_scc1 L_end
    s_waitcnt vmcnt(0)
    v_max3_u32 v5, v149, v151, v153
    v_max3_u32 v5, v5, v155, v157
    v_max3_u32 v5, v5, v159, v161
    v_max_u32 v5, v5, v163
    v_cmpx_le_u32 vcc, 0xffff0000, v5
    s_cbranch_execnz Lpoll12r
    s_mov_b64 exec, -1
    s_branch Lok13
Lpoll14:
    s_mov_b32 s15, 1048576
    s_mov_b64 exec, vcc
Lpoll14r:
    s_sleep 2
    global_load_dwordx4 v[164:167], v3, s[4:5] offset:1536 sc1
    global_load_dwordx4 v[168:171], v3, s[4:5] offset:1664 sc1
    global_load_dwordx4 v[172:175], v3, s[4:5] offset:1792 sc1
    global_load_dwordx4 v[176:179], v3, s[4:5] offset:1920 sc1
    s_sub_u32 s15, s15, 1
    s_cbranch_scc1 L_end
    s_waitcnt vmcnt(0)
    v_max3_u32 v5, v165, v167, v169
    v_max3_u32 v5, v5, v171, v173
    v_max3_u32 v5, v5, v175, v177
    v_max_u32 v5, v5, v179
    v_cmpx_le_u32 vcc, 0xffff0000, v5
    s_cbranch_execnz Lpoll14r
    s_mov_b64 exec, -1
    s_branch Lok15
Lpoll16:
    s_mov_b32 s15, 1048576
    s_mov_b64 exec, vcc
Lpoll16r:
    s_sleep 2
    global_load_dwordx4 v[184:187], v3, s[4:5] offset:2176 sc1
    global_load_dwordx4 v[188:191], v3, s[4:5] offset:2304 sc1
    global_load_dwordx4 v[192:195], v3, s[4:5] offset:2432 sc1
    s_sub_u32 s15, s15, 1
    s_cbranch_scc1 L_end
    s_waitcnt vmcnt(0)
    v_max3_u32 v5, v185, v187, v189
    v_max3_u32 v5, v5, v191, v193
    v_max_u32 v5, v5, v195
    v_cmpx_le_u32 vcc, 0xffff0000, v5
    s_cbranch_execnz Lpoll16r
    s_mov_b64 exec, -1
    s_branch Lok17
Lpoll18:
    s_mov_b32 s15, 1048576
    s_mov_b64 exec, vcc
Lpoll18r:
    s_sleep 2
    global_load_dwordx4 v[196:199], v3, s[4:5] offset:2560 sc1
    global_load_dwordx4 v[200:203], v3, s[4:5] offset:2688 sc1
    global_load_dwordx4 v[204:207], v3, s[4:5] offset:2816 sc1
    global_load_dwordx4 v[208:211], v3, s[4:5] offset:2944 sc1
    s_sub_u32 s15, s15, 1
    s_cbranch_scc1 L_end
    s_waitcnt vmcnt(0)
    v_max3_u32 v5, v197, v199, v201
    v_max3_u32 v5, v5, v203, v205
    v_max3_u32 v5, v5, v207, v209
    v_max_u32 v5, v5, v211
    v_cmpx_le_u32 vcc, 0xffff0000, v5
    s_cbranch_execnz Lpoll18r
    s_mov_b64 exec, -1
    s_branch Lok19
Lpoll20:
    s_mov_b32 s15, 1048576
    s_mov_b64 exec, vcc
Lpoll20r:
    s_sleep 2
    global_load_dwordx4 v[212:215], v3, s[4:5] offset:3072 sc1
    global_load_dwordx4 v[216:219], v3, s[4:5] offset:3200 sc1
    global_load_dwordx4 v[220:223], v3, s[4:5] offset:3328 sc1
    global_load_dwordx4 v[224:227], v3, s[4:5] offset:3456 sc1
    s_sub_u32 s15, s15, 1
    s_cbranch_scc1 L_end
    s_waitcnt vmcnt(0)
    v_max3_u32 v5, v213, v215, v217
    v_max3_u32 v5, v5, v219, v221
    v_max3_u32 v5, v5, v223, v225
    v_max_u32 v5, v5, v227
    v_cmpx_le_u32 vcc, 0xffff0000, v5
    s_cbranch_execnz Lpoll20r
    s_mov_b64 exec, -1
    s_branch Lok21
Lpoll22:
    s_mov_b32 s15, 1048576
    s_mov_b64 exec, vcc
Lpoll22r:
    s_sleep 2
    global_load_dwordx4 v[228:231], v3, s[4:5] offset:3584 sc1
    global_load_dwordx4 v[232:235], v3, s[4:5] offset:3712 sc1
    global_load_dwordx4 v[236:239], v3, s[4:5] offset:3840 sc1
    global_load_dwordx4 v[240:243], v3, s[4:5] offset:3968 sc1
    s_sub_u32 s15, s15, 1
    s_cbranch_scc1 L_end
    s_waitcnt vmcnt(0)
    v_max3_u32 v5, v229, v231, v233
    v_max3_u32 v5, v5, v235, v237
    v_max3_u32 v5, v5, v239, v241
    v_max_u32 v5, v5, v243
    v_cmpx_le_u32 vcc, 0xffff0000, v5
    s_cbranch_execnz Lpoll22r
    s_mov_b64 exec, -1
    s_branch Lok23
Lpoll35:
    s_mov_b32 s15, 1048576
    s_mov_b64 exec, vcc
Lpoll35r:
    s_sleep 8
    global_load_dwordx4 v[8:11], v36, s[56:57] sc1
    s_sub_u32 s15, s15, 1
    s_cbranch_scc1 L_end
    s_waitcnt vmcnt(0)
    v_and_b32 v4, v9, v11
    v_or_b32 v5, v9, v11
    v_xor_b32 v4, s40, v4
    v_xor_b32 v5, s40, v5
    v_or_b32 v4, v4, v5
    v_cmpx_ne_u32 vcc, 0, v4
    s_cbranch_execnz Lpoll35r
    s_mov_b64 exec, -1
    s_branch Lok36
Lpoll38:
    s_mov_b32 s15, 1048576
    s_mov_b64 exec, vcc
Lpoll38r:
    s_sleep 2
    global_load_dwordx4 v[8:11], v16, s[48:49] offset:0 sc1
    s_sub_u32 s15, s15, 1
    s_cbranch_scc1 L_end
    s_waitcnt vmcnt(0)
    v_and_b32 v4, v9, v11
    v_or_b32 v5, v9, v11
    v_xor_b32 v4, s40, v4
    v_xor_b32 v5, s40, v5
    v_or_b32 v4, v4, v5
    v_cmpx_ne_u32 vcc, 0, v4
    s_cbranch_execnz Lpoll38r
    s_mov_b64 exec, -1
    s_branch Lok39
Lpoll41:
    s_mov_b32 s15, 1048576
    s_mov_b64 exec, vcc
Lpoll41r:
    s_sleep 2
    global_load_dwordx4 v[8:11], v16, s[48:49] offset:128 sc1
    s_sub_u32 s15, s15, 1
    s_cbranch_scc1 L_end
    s_waitcnt vmcnt(0)
    v_and_b32 v4, v9, v11
    v_or_b32 v5, v9, v11
    v_xor_b32 v4, s40, v4
    v_xor_b32 v5, s40, v5
    v_or_b32 v4, v4, v5
    v_cmpx_ne_u32 vcc, 0, v4
    s_cbranch_execnz Lpoll41r
    s_mov_b64 exec, -1
    s_branch Lok42
Lpoll45:
    s_mov_b32 s15, 1048576
    s_mov_b64 exec, vcc
Lpoll45r:
    s_sleep 2
    global_load_dwordx4 v[120:123], v3, s[10:11] offset:1024 sc1
    global_load_dwordx4 v[124:127], v19, s[10:11] offset:1024 sc1
    s_sub_u32 s15, s15, 1
    s_cbranch_scc1 L_end
    s_waitcnt vmcnt(0)
    v_max3_u32 v4, v121, v123, v125
    v_max_u32 v4, v4, v127
    v_cmpx_le_u32 vcc, 0xffff0000, v4
    s_cbranch_execnz Lpoll45r
    s_mov_b64 exec, -1
    s_branch Lok46
Lpoll47:
    s_mov_b32 s15, 1048576
    s_mov_b64 exec, vcc
Lpoll47r:
    s_sleep 2
    global_load_dwordx4 v[224:227], v3, s[12:13] offset:1024 sc1
    global_load_dwordx4 v[228:231], v19, s[12:13] offset:1024 sc1
    s_sub_u32 s15, s15, 1
    s_cbranch_scc1 L_end
    s_waitcnt vmcnt(0)
    v_max3_u32 v4, v225, v227, v229
    v_max_u32 v4, v4, v231
    v_cmpx_le_u32 vcc, 0xffff0000, v4
    s_cbranch_execnz Lpoll47r
    s_mov_b64 exec, -1
    s_branch Lok48
Lpoll49:
    s_mov_b32 s15, 1048576
    s_mov_b64 exec, vcc
Lpoll49r:
    s_sleep 2
    global_load_dwordx4 v[128:131], v3, s[50:51] offset:1024 sc1
    global_load_dwordx4 v[132:135], v19, s[50:51] offset:1024 sc1
    s_sub_u32 s15, s15, 1
    s_cbranch_scc1 L_end
    s_waitcnt vmcnt(0)
    v_max3_u32 v4, v129, v131, v133
    v_max_u32 v4, v4, v135
    v_cmpx_le_u32 vcc, 0xffff0000, v4
    s_cbranch_execnz Lpoll49r
    s_mov_b64 exec, -1
    s_branch Lok50
Lpoll51:
    s_mov_b32 s15, 1048576
    s_mov_b64 exec, vcc
Lpoll51r:
    s_sleep 2
    global_load_dwordx4 v[232:235], v3, s[54:55] offset:1024 sc1
    global_load_dwordx4 v[236:239], v19, s[54:55] offset:1024 sc1
    s_sub_u32 s15, s15, 1
    s_cbranch_scc1 L_end
    s_waitcnt vmcnt(0)
    v_max3_u32 v4, v233, v235, v237
    v_max_u32 v4, v4, v239
    v_cmpx_le_u32 vcc, 0xffff0000, v4
    s_cbranch_execnz Lpoll51r
    s_mov_b64 exec, -1
    s_branch Lok52
Lpoll53:
    s_mov_b32 s15, 1048576
    s_mov_b64 exec, vcc
Lpoll53r:
    s_sleep 2
    global_load_dwordx4 v[152:155], v3, s[10:11] offset:2048 sc1
    global_load_dwordx4 v[156:159], v19, s[10:11] offset:2048 sc1
    s_sub_u32 s15, s15, 1
    s_cbranch_scc1 L_end
    s_waitcnt vmcnt(0)
    v_max3_u32 v4, v153, v155, v157
    v_max_u32 v4, v4, v159
    v_cmpx_le_u32 vcc, 0xffff0000, v4
    s_cbranch_execnz Lpoll53r
    s_mov_b64 exec, -1
    s_branch Lok54
Lpoll55:
    s_mov_b32 s15, 1048576
    s_mov_b64 exec, vcc
Lpoll55r:
    s_sleep 2
    global_load_dwordx4 v[88:91], v3, s[12:13] offset:2048 sc1
    global_load_dwordx4 v[92:95], v19, s[12:13] offset:2048 sc1
    s_sub_u32 s15, s15, 1
    s_cbranch_scc1 L_end
    s_waitcnt vmcnt(0)
    v_max3_u32 v4, v89, v91, v93
    v_max_u32 v4, v4, v95
    v_cmpx_le_u32 vcc, 0xffff0000, v4
    s_cbranch_execnz Lpoll55r
    s_mov_b64 exec, -1
    s_branch Lok56
Lpoll57:
    s_mov_b32 s15, 1048576
    s_mov_b64 exec, vcc
Lpoll57r:
    s_sleep 2
    global_load_dwordx4 v[160:163], v3, s[50:51] offset:2048 sc1
    global_load_dwordx4 v[164:167], v19, s[50:51] offset:2048 sc1
    s_sub_u32 s15, s15, 1
    s_cbranch_scc1 L_end
    s_waitcnt vmcnt(0)
    v_max3_u32 v4, v161, v163, v165
    v_max_u32 v4, v4, v167
    v_cmpx_le_u32 vcc, 0xffff0000, v4
    s_cbranch_execnz Lpoll57r
    s_mov_b64 exec, -1
    s_branch Lok58
Lpoll59:
    s_mov_b32 s15, 1048576
    s_mov_b64 exec, vcc
Lpoll59r:
    s_sleep 2
    global_load_dwordx4 v[192:195], v3, s[54:55] offset:2048 sc1
    global_load_dwordx4 v[196:199], v19, s[54:55] offset:2048 sc1
    s_sub_u32 s15, s15, 1
    s_cbranch_scc1 L_end
    s_waitcnt vmcnt(0)
    v_max3_u32 v4, v193, v195, v197
    v_max_u32 v4, v4, v199
    v_cmpx_le_u32 vcc, 0xffff0000, v4
    s_cbranch_execnz Lpoll59r
    s_mov_b64 exec, -1
    s_branch Lok60
Lpoll61:
    s_mov_b32 s15, 1048576
    s_mov_b64 exec, vcc
Lpoll61r:
    s_sleep 2
    global_load_dwordx4 v[136:139], v3, s[10:11] offset:3072 sc1
    global_load_dwordx4 v[140:143], v19, s[10:11] offset:3072 sc1
    s_sub_u32 s15, s15, 1
    s_cbranch_scc1 L_end
    s_waitcnt vmcnt(0)
    v_max3_u32 v4, v137, v139, v141
    v_max_u32 v4, v4, v143
    v_cmpx_le_u32 vcc, 0xffff0000, v4
    s_cbranch_execnz Lpoll61r
    s_mov_b64 exec, -1
    s_branch Lok62
Lpoll63:
    s_mov_b32 s15, 1048576
    s_mov_b64 exec, vcc
Lpoll63r:
    s_sleep 2
    global_load_dwordx4 v[208:211], v3, s[12:13] offset:3072 sc1
    global_load_dwordx4 v[212:215], v19, s[12:13] offset:3072 sc1
    s_sub_u32 s15, s15, 1
    s_cbranch_scc1 L_end
    s_waitcnt vmcnt(0)
    v_max3_u32 v4, v209, v211, v213
    v_max_u32 v4, v4, v215
    v_cmpx_le_u32 vcc, 0xffff0000, v4
    s_cbranch_execnz Lpoll63r
    s_mov_b64 exec, -1
    s_branch Lok64
Lpoll65:
    s_mov_b32 s15, 1048576
    s_mov_b64 exec, vcc
Lpoll65r:
    s_sleep 2
    global_load_dwordx4 v[240:243], v3, s[50:51] offset:3072 sc1
    global_load_dwordx4 v[244:247], v19, s[50:51] offset:3072 sc1
    s_sub_u32 s15, s15, 1
    s_cbranch_scc1 L_end
    s_waitcnt vmcnt(0)
    v_max3_u32 v4, v241, v243, v245
    v_max_u32 v4, v4, v247
    v_cmpx_le_u32 vcc, 0xffff0000, v4
    s_cbranch_execnz Lpoll65r
    s_mov_b64 exec, -1
    s_branch Lok66
Lpoll67:
    s_mov_b32 s15, 1048576
    s_mov_b64 exec, vcc
Lpoll67r:
    s_sleep 2
    global_load_dwordx4 v[112:115], v3, s[54:55] offset:3072 sc1
    global_load_dwordx4 v[116:119], v19, s[54:55] offset:3072 sc1
    s_sub_u32 s15, s15, 1
    s_cbranch_scc1 L_end
    s_waitcnt vmcnt(0)
    v_max3_u32 v4, v113, v115, v117
    v_max_u32 v4, v4, v119
    v_cmpx_le_u32 vcc, 0xffff0000, v4
    s_cbranch_execnz Lpoll67r
    s_mov_b64 exec, -1
    s_branch Lok68
L_end:
    s_endpgm

.section .rodata,"a"
.p2align 6
.amdhsa_kernel sequential_preLN__spectral_gfnet__glu_gated_glu__prompt_kernel
  .amdhsa_next_free_vgpr 256
  .amdhsa_next_free_sgpr 96
  .amdhsa_accum_offset 256
  .amdhsa_group_segment_fixed_size 0
  .amdhsa_kernarg_size 80
  .amdhsa_user_sgpr_count 2
  .amdhsa_user_sgpr_kernarg_segment_ptr 1
  .amdhsa_system_sgpr_workgroup_id_x 1
  .amdhsa_float_denorm_mode_32 3
  .amdhsa_float_denorm_mode_16_64 3
.end_amdhsa_kernel
```
